```python
import torch

def _softmax(x, axis=-1):
    return torch.softmax(x, dim=axis)
def _gelu(x):
    return torch.nn.functional.gelu(x, approximate="tanh")
def _silu(x):
    return torch.nn.functional.silu(x)
def _sigmoid(x):
    return torch.sigmoid(x)
def _layernorm(x, axis=-1, eps=1e-5):
    m = x.mean(dim=axis, keepdim=True)
    v = x.var(dim=axis, keepdim=True, unbiased=False)
    return (x - m) / torch.sqrt(v + eps)
def _scatter_add(tgt, idx, src, axis=0):
    return tgt.clone().index_add_(axis, idx, src)
def _segment_sum(src, seg, n):
    out = torch.zeros((n,) + src.shape[1:], dtype=src.dtype)
    return out.index_add_(0, seg, src)
def _pad(x, pw):
    flat = tuple(v for pair in reversed(pw) for v in pair)
    return torch.nn.functional.pad(x, flat)

kernel_name = 'gated_mix__grouped_kv_mqa__dense_activation_relu__prompt'

def setup_inputs():

    _w = (lambda a: (lambda t: t.to(torch.bfloat16) if t.is_floating_point() else t)(torch.as_tensor(a)))
    def _A_setup():
        B, S, D, H = 1, 2048, 448, 16
        Dh = D // H
        return {
            "x": _w((lambda *s: torch.randn(*s, dtype=torch.bfloat16) * 0.05)(B, S, D)),
            "wq": _w((lambda *s: torch.randn(*s, dtype=torch.bfloat16) * 1.6)(D, H * Dh)),
            "wk": _w((lambda *s: torch.randn(*s, dtype=torch.bfloat16) * 1.6)(D, Dh)),
            "wv": _w((lambda *s: torch.randn(*s, dtype=torch.bfloat16) * 0.2)(D, Dh)),
            "wo": _w((lambda *s: torch.randn(*s, dtype=torch.bfloat16) * 0.2)(H * Dh, D)),
        }
    _A_in = _A_setup()

    def _B_setup():
        B, S, D, Dff = 1, 2048, 448, 1792
        return {
            "x": _w((lambda *s: torch.randn(*s, dtype=torch.bfloat16) * 0.05)(B, S, D)),
            "w1": _w((lambda *s: torch.randn(*s, dtype=torch.bfloat16) * 0.2)(D, Dff)),
            "w2": _w((lambda *s: torch.randn(*s, dtype=torch.bfloat16) * 0.2)(Dff, D)),
        }
    _B_in = _B_setup()

    return {
        "A_x": _A_in["x"],
        "A_wq": _A_in["wq"],
        "A_wk": _A_in["wk"],
        "A_wv": _A_in["wv"],
        "A_wo": _A_in["wo"],
        "B_x": _B_in["x"],
        "B_w1": _B_in["w1"],
        "B_w2": _B_in["w2"],
        "gate_w": _w((lambda *s: torch.randn(*s, dtype=torch.bfloat16) * 0.05)(448) * 16.0),
    }

def reference(A_x, A_wq, A_wk, A_wv, A_wo, B_x, B_w1, B_w2, gate_w):
    def _A_ref(x, wq, wk, wv, wo):
        B, S, D = x.shape
        H = 16
        Dh = D // H
        q = (lambda x, *d: x.permute(*d))((x @ wq).reshape(B, S, H, Dh), 0, 2, 1, 3)
        k = x @ wk
        v = x @ wv
        scores = torch.einsum("bhqd,bkd->bhqk", q, k) * (Dh ** -0.5)
        p = _softmax(scores, axis=-1)
        o = torch.einsum("bhqk,bkd->bhqd", p, v)
        return (lambda x, *d: x.permute(*d))(o, 0, 2, 1, 3).reshape(B, S, H * Dh) @ wo

    def _B_ref(x, w1, w2):
        h = torch.einsum("bsd,df->bsf", x, w1)
        zero = torch.zeros_like(h)
        h = torch.maximum(h, zero)
        return torch.einsum("bsf,fd->bsd", h, w2)

    x = A_x
    g = _sigmoid((x * gate_w).sum(-1, keepdims=True))
    a = _A_ref(x, A_wq, A_wk, A_wv, A_wo)
    b = _B_ref(x, B_w1, B_w2)
    return g * a + (1 - g) * b
```

```asm
; @launch grid=(256,1,1) block=(256,1,1) lds=163840
.amdgcn_target "amdgcn-amd-amdhsa--gfx950"
.text
.globl gated_mix__grouped_kv_mqa__dense_activation_relu__prompt_kernel
.p2align 8
.type gated_mix__grouped_kv_mqa__dense_activation_relu__prompt_kernel,@function
gated_mix__grouped_kv_mqa__dense_activation_relu__prompt_kernel:
  s_cmp_ge_u32 s2, 256
  s_cbranch_scc1 L_end
  s_load_dwordx16 s[8:23], s[0:1], 0
  s_load_dwordx8 s[92:99], s[0:1], 64
  v_lshrrev_b32 v3, 6, v0
  v_and_b32 v1, 63, v0
  s_bfe_u32 s52, s2, 0x20001
  v_readfirstlane_b32 s46, v3
  s_lshl_b32 s52, s52, 2
  s_bfe_u32 s53, s2, 0x20003
  s_or_b32 s44, s52, s53
  s_and_b32 s64, s2, 1
  s_lshr_b32 s65, s2, 5
  s_lshl_b32 s45, s64, 3
  s_or_b32 s45, s45, s65
  v_lshlrev_b32 v2, 4, v1
  s_add_u32 s2, s44, 1
  s_lshl_b32 s2, s2, 20
  s_mul_i32 s47, s46, 28672
  s_lshl_b32 s56, s44, 2
  s_add_u32 s56, s56, s46
  s_lshl_b32 s52, s44, 1
  s_add_u32 s52, s52, s45
  s_mul_i32 s53, s52, 37
  s_lshr_b32 s53, s53, 8
  s_mul_i32 s53, s53, 7
  s_sub_u32 s49, s52, s53
  v_lshrrev_b32 v7, 3, v1
  v_mul_u32_u24 v3, 896, v7
  v_and_b32 v4, 7, v1
  v_lshrrev_b32 v5, 4, v1
  v_xor_b32 v5, v4, v5
  v_lshl_add_u32 v8, v5, 4, v3
  v_xor_b32 v5, 4, v5
  v_lshl_add_u32 v9, v5, 4, v3
  v_add_u32 v10, 12288, v8
  v_add_u32 v11, 18432, v9
  v_add_u32 v9, 6144, v9
  v_bfe_u32 v5, v1, 4, 1
  v_lshlrev_b32 v5, 2, v5
  v_xor_b32 v5, v4, v5
  v_lshlrev_b32 v17, 4, v5
  v_add_u32 v240, v17, v3
  v_lshrrev_b32 v3, 2, v1
  v_and_b32 v4, 3, v1
  v_lshlrev_b32 v4, 4, v4
  s_cmp_lt_u32 s65, 1
  s_cselect_b32 s59, 1, 0
  s_waitcnt lgkmcnt(0)
  s_load_dword s90, s[8:9], 0
  s_load_dword s90, s[10:11], 0
  s_load_dword s90, s[20:21], 0
  s_load_dword s90, s[12:13], 0
  s_load_dword s90, s[14:15], 0
  s_load_dword s90, s[22:23], 0
  s_load_dword s90, s[16:17], 0
  s_load_dword s90, s[94:95], 0
  s_load_dword s90, s[98:99], 655360
  s_add_u32 s52, s2, 655360
  s_load_dword s90, s[98:99], s52
  s_mov_b64 s[4:5], s[20:21]
  s_mov_b64 s[6:7], s[10:11]
  s_mov_b64 s[42:43], s[22:23]
  s_mov_b32 s24, s16
  s_and_b32 s25, s17, 0xffff
  s_mov_b32 s26, 401408
  s_mov_b32 s27, 0x20000
  s_mov_b64 s[100:101], s[12:13]
  s_mov_b32 s48, 56
  s_mov_b32 s55, 25088
  s_mov_b32 s54, 0
  s_cmp_eq_u32 s45, 0
  s_cbranch_scc1 L_w0done
  s_mov_b64 s[100:101], s[14:15]
  s_cmp_eq_u32 s45, 8
  s_cbranch_scc1 L_w0done
  s_mov_b64 s[100:101], s[6:7]
  s_mov_b32 s48, 896
  s_mov_b32 s55, 401408
  s_mul_i32 s54, s45, 56
L_w0done:
  s_mov_b32 s12, s100
  s_and_b32 s13, s101, 0xffff
  s_mov_b32 s14, s55
  s_mov_b32 s15, 0x20000
  s_mov_b32 s8, s8
  s_and_b32 s9, s9, 0xffff
  s_mov_b32 s10, 1835008
  s_mov_b32 s11, 0x20000
  v_mad_u32_u24 v16, v3, s48, v4
  s_lshl_b32 s48, s48, 4
  s_mul_i32 s53, s46, s48
  s_add_u32 s54, s54, s53
  s_lshl_b32 s48, s48, 2
  s_mul_i32 s55, s56, 28672
  s_lshl_b32 s52, s65, 1
  s_mul_i32 s53, s64, 14
  s_add_u32 s68, s52, s53
  s_sub_u32 s68, s68, 2
  s_lshr_b32 s53, s46, 1
  s_add_u32 s52, s68, s53
  s_lshl_b32 s51, s52, 7
  s_and_b32 s52, s46, 1
  s_add_u32 s68, s68, s52
  s_mul_i32 s52, s52, 114688
  s_add_u32 s51, s51, s52
  s_mov_b32 s16, s4
  s_and_b32 s17, s5, 0xffff
  s_mov_b32 s18, 1605632
  s_mov_b32 s19, 0x20000
  s_mov_b32 s50, 3584
  v_mad_u32_u24 v17, v7, s50, v17
  v_add_u32 v18, 27648, v17
  v_add_u32 v19, 27648, v18
  v_add_u32 v20, 27648, v19
  s_mov_b64 s[100:101], s[92:93]
  s_lshl_b32 s92, s46, 10
  s_lshl_b32 s93, s46, 12
  s_cmp_eq_u32 s59, 1
  s_cbranch_scc1 L_i2
  s_lshl2_add_u32 s53, s45, s46
  s_cmp_eq_u32 s53, 28
  s_cbranch_scc1 L_z1
L_z1r:
  s_mov_b32 s3, s49
  s_mul_i32 s53, s3, s48
  s_add_u32 m0, s92, 131072
  s_add_u32 s53, s53, s54
  buffer_load_dwordx4 v16, s[12:15], s53 offen  lds
  s_lshl_b32 s53, s3, 7
  s_add_u32 m0, s93, 0
  s_add_u32 s53, s53, s55
  buffer_load_dwordx4 v8, s[8:11], s53 offen offset:0  lds
  buffer_load_dwordx4 v9, s[8:11], s53 offen offset:1024  lds
  buffer_load_dwordx4 v10, s[8:11], s53 offen offset:2048  lds
  buffer_load_dwordx4 v11, s[8:11], s53 offen offset:3072  lds
  s_mul_i32 s53, s3, 229376
  s_add_u32 m0, s93, 65536
  s_add_u32 s53, s53, s51
  buffer_load_dwordx4 v17, s[16:19], s53 offen offset:0  lds
  buffer_load_dwordx4 v18, s[16:19], s53 offen offset:1024  lds
  buffer_load_dwordx4 v19, s[16:19], s53 offen offset:2048  lds
  buffer_load_dwordx4 v20, s[16:19], s53 offen offset:3072  lds
  s_lshl2_add_u32 s53, s45, s46
  s_cmp_eq_u32 s53, 28
  s_cbranch_scc1 L_z2
L_z2r:
  s_add_u32 s3, s3, 1
  s_cmp_eq_u32 s3, 7
  s_cselect_b32 s3, 0, s3
  s_mul_i32 s53, s3, s48
  s_add_u32 m0, s92, 135168
  s_add_u32 s53, s53, s54
  buffer_load_dwordx4 v16, s[12:15], s53 offen  lds
  s_lshl_b32 s53, s3, 7
  s_add_u32 m0, s93, 16384
  s_add_u32 s53, s53, s55
  buffer_load_dwordx4 v8, s[8:11], s53 offen offset:0  lds
  buffer_load_dwordx4 v9, s[8:11], s53 offen offset:1024  lds
  buffer_load_dwordx4 v10, s[8:11], s53 offen offset:2048  lds
  buffer_load_dwordx4 v11, s[8:11], s53 offen offset:3072  lds
  s_mul_i32 s53, s3, 229376
  s_add_u32 m0, s93, 81920
  s_add_u32 s53, s53, s51
  buffer_load_dwordx4 v17, s[16:19], s53 offen offset:0  lds
  buffer_load_dwordx4 v18, s[16:19], s53 offen offset:1024  lds
  buffer_load_dwordx4 v19, s[16:19], s53 offen offset:2048  lds
  buffer_load_dwordx4 v20, s[16:19], s53 offen offset:3072  lds
L_i3:
  s_getpc_b64 s[4:5]
L_pc:
  s_mul_i32 s53, s46, 8192
  v_lshlrev_b32 v5, 7, v1
  v_add_u32 v5, s53, v5
  v_min_u32 v5, L_end-L_pc, v5
  global_load_dword v28, v5, s[4:5]
  s_mov_b32 s20, s98
  s_and_b32 s21, s99, 0xffff
  s_mov_b32 s22, 33554432
  s_mov_b32 s23, 0x20000
  s_mov_b32 s28, s94
  s_and_b32 s29, s95, 0xffff
  s_mov_b32 s30, 1835008
  s_mov_b32 s31, 0x20000
  s_mov_b32 s32, s96
  s_and_b32 s33, s97, 0xffff
  s_mov_b32 s34, 256
  s_mov_b32 s35, 0x20000
  s_mov_b32 s66, 0
  s_mov_b32 s67, -1
  v_add_u32 v241, 6144, v240
  v_add_u32 v242, 12288, v240
  v_add_u32 v243, 18432, v240
  v_and_b32 v3, 31, v1
  v_lshrrev_b32 v4, 5, v1
  v_bfe_u32 v5, v1, 1, 3
  v_xor_b32 v5, v4, v5
  v_lshlrev_b32 v3, 7, v3
  v_add_u32 v3, s93, v3
  v_xor_b32 v6, 0, v5
  v_lshl_add_u32 v12, v6, 4, v3
  v_xor_b32 v252, 0x1000, v12
  v_xor_b32 v6, 2, v5
  v_lshl_add_u32 v13, v6, 4, v3
  v_xor_b32 v253, 0x1000, v13
  v_xor_b32 v6, 4, v5
  v_lshl_add_u32 v14, v6, 4, v3
  v_xor_b32 v254, 0x1000, v14
  v_xor_b32 v6, 6, v5
  v_lshl_add_u32 v15, v6, 4, v3
  v_xor_b32 v255, 0x1000, v15
  v_bfe_u32 v3, v1, 2, 2
  v_bfe_u32 v5, v1, 4, 1
  v_and_b32 v6, 3, v1
  v_lshlrev_b32 v6, 3, v6
  v_lshl_add_u32 v6, v5, 5, v6
  v_lshl_add_u32 v5, v4, 3, v3
  v_lshl_add_u32 v21, v5, 6, v6
  s_cmp_eq_u32 s59, 1
  s_cselect_b32 s52, -16384, 0
  s_add_u32 s52, s52, 131072
  v_mov_b32 v24, v21
  v_add_u32 v25, 57344, v21
  v_add_u32 v21, s52, v21
  s_and_b32 s53, s46, 1
  s_lshl_b32 s53, s53, 13
  s_add_u32 s53, s53, 65536
  v_bfe_u32 v7, v1, 3, 1
  v_lshl_add_u32 v6, v7, 6, v6
  v_lshl_add_u32 v22, v5, 7, v6
  v_add_u32 v22, s53, v22
  v_xor_b32 v23, 64, v22
  v_lshl_add_u32 v5, v4, 2, v3
  v_lshl_add_u32 v6, v5, 7, v6
  s_and_b32 s52, s46, 1
  s_lshl_b32 s52, s52, 6
  v_xor_b32 v6, s52, v6
  v_add_u32 v26, s47, v6
  v_xor_b32 v6, 64, v6
  v_add_u32 v27, s47, v6
  s_lshr_b32 s52, s46, 1
  s_xor_b32 s53, s52, 1
  s_mul_i32 s69, s52, 114688
  v_add_u32 v244, s69, v2
  s_lshl_b32 s69, s52, 15
  v_add_u32 v246, s69, v2
  s_mul_i32 s69, s53, 114688
  v_add_u32 v245, s69, v2
  s_lshl_b32 s69, s53, 15
  v_add_u32 v247, s69, v2
  v_mov_b32 v248, 1
  v_lshlrev_b32 v249, 25, v1
  v_mov_b32 v250, 0
  s_add_u32 s58, s2, 593920
  s_lshl_b32 s52, s64, 1
  s_mul_i32 s60, s52, 114688
  s_mul_i32 s53, s46, 28672
  s_add_u32 s60, s60, s53
  s_add_u32 s60, s60, s2
  s_lshl_b32 s63, s52, 15
  s_lshl_b32 s53, s46, 13
  s_add_u32 s63, s63, s53
  s_add_u32 s63, s63, 462848
  s_add_u32 s63, s63, s2
  s_min_u32 s53, s65, 6
  s_lshl_b32 s53, s53, 7
  s_mul_i32 s61, s46, 401408
  s_add_u32 s61, s61, s53
  s_mul_i32 s62, s46, 100352
  s_add_u32 s62, s62, s53
  s_mov_b32 s57, 0
  s_lshl1_add_u32 s53, s44, s64
  s_lshl_b32 s52, s65, 5
  s_add_u32 s53, s53, s52
  s_and_b32 s53, s53, 31
  s_mul_i32 s53, s53, 0x1100
  s_add_u32 s53, s53, 524288
  v_and_b32 v160, 31, v0
  v_lshl_add_u32 v160, v160, 2, s53
  v_lshlrev_b32 v162, 8, v0
  s_cmp_eq_u32 s59, 1
  s_cbranch_scc1 L_sp
  s_waitcnt vmcnt(10)
  s_barrier
  v_lshlrev_b32 v6, 8, v0
  ds_read_b64_tr_b16 v[48:49], v21 offset:0
  ds_read_b64_tr_b16 v[50:51], v21 offset:256
  ds_read_b128 v[144:147], v12 offset:0
  ds_read_b128 v[148:151], v252 offset:0
  ds_read_b64_tr_b16 v[32:33], v22 offset:0
  ds_read_b64_tr_b16 v[34:35], v22 offset:512
  ds_read_b64_tr_b16 v[36:37], v23 offset:0
  ds_read_b64_tr_b16 v[38:39], v23 offset:512
  s_waitcnt lgkmcnt(0)
  v_mfma_f32_32x32x16_bf16 v[128:143], v[48:51], v[144:147], 0
  ds_read_b64_tr_b16 v[40:41], v22 offset:2048
  ds_read_b64_tr_b16 v[42:43], v22 offset:2560
  v_mfma_f32_32x32x16_bf16 v[64:79], v[32:35], v[144:147], 0
  ds_read_b64_tr_b16 v[44:45], v23 offset:2048
  ds_read_b64_tr_b16 v[46:47], v23 offset:2560
  v_mfma_f32_32x32x16_bf16 v[80:95], v[36:39], v[144:147], 0
  ds_read_b64_tr_b16 v[52:53], v21 offset:1024
  ds_read_b64_tr_b16 v[54:55], v21 offset:1280
  s_add_u32 s3, s3, 1
  s_cmp_eq_u32 s3, 7
  s_cselect_b32 s3, 0, s3
  v_mfma_f32_32x32x16_bf16 v[96:111], v[32:35], v[148:151], 0
  ds_read_b128 v[152:155], v13 offset:0
  s_mul_i32 s53, s3, s48
  s_add_u32 m0, s92, 139264
  s_add_u32 s53, s53, s54
  v_mfma_f32_32x32x16_bf16 v[112:127], v[36:39], v[148:151], 0
  ds_read_b128 v[156:159], v253 offset:0
  buffer_load_dwordx4 v16, s[12:15], s53 offen  lds
  s_lshl_b32 s53, s3, 7
  s_add_u32 m0, s93, 32768
  s_add_u32 s53, s53, s55
  s_waitcnt lgkmcnt(0)
  v_mfma_f32_32x32x16_bf16 v[128:143], v[52:55], v[152:155], v[128:143]
  ds_read_b64_tr_b16 v[32:33], v22 offset:4096
  ds_read_b64_tr_b16 v[34:35], v22 offset:4608
  v_mfma_f32_32x32x16_bf16 v[64:79], v[40:43], v[152:155], v[64:79]
  ds_read_b64_tr_b16 v[36:37], v23 offset:4096
  ds_read_b64_tr_b16 v[38:39], v23 offset:4608
  v_mfma_f32_32x32x16_bf16 v[80:95], v[44:47], v[152:155], v[80:95]
  ds_read_b64_tr_b16 v[48:49], v21 offset:2048
  ds_read_b64_tr_b16 v[50:51], v21 offset:2304
  buffer_load_dwordx4 v8, s[8:11], s53 offen offset:0  lds
  v_mfma_f32_32x32x16_bf16 v[96:111], v[40:43], v[156:159], v[96:111]
  ds_read_b128 v[144:147], v14 offset:0
  buffer_load_dwordx4 v9, s[8:11], s53 offen offset:1024  lds
  v_mfma_f32_32x32x16_bf16 v[112:127], v[44:47], v[156:159], v[112:127]
  ds_read_b128 v[148:151], v254 offset:0
  buffer_load_dwordx4 v10, s[8:11], s53 offen offset:2048  lds
  buffer_load_dwordx4 v11, s[8:11], s53 offen offset:3072  lds
  s_waitcnt lgkmcnt(0)
  v_mfma_f32_32x32x16_bf16 v[128:143], v[48:51], v[144:147], v[128:143]
  ds_read_b64_tr_b16 v[40:41], v22 offset:6144
  ds_read_b64_tr_b16 v[42:43], v22 offset:6656
  v_mfma_f32_32x32x16_bf16 v[64:79], v[32:35], v[144:147], v[64:79]
  ds_read_b64_tr_b16 v[44:45], v23 offset:6144
  ds_read_b64_tr_b16 v[46:47], v23 offset:6656
  v_mfma_f32_32x32x16_bf16 v[80:95], v[36:39], v[144:147], v[80:95]
  ds_read_b64_tr_b16 v[52:53], v21 offset:3072
  ds_read_b64_tr_b16 v[54:55], v21 offset:3328
  s_mul_i32 s53, s3, 229376
  s_add_u32 m0, s93, 98304
  s_add_u32 s53, s53, s51
  v_mfma_f32_32x32x16_bf16 v[96:111], v[32:35], v[148:151], v[96:111]
  ds_read_b128 v[152:155], v15 offset:0
  buffer_load_dwordx4 v17, s[16:19], s53 offen offset:0  lds
  v_mfma_f32_32x32x16_bf16 v[112:127], v[36:39], v[148:151], v[112:127]
  ds_read_b128 v[156:159], v255 offset:0
  buffer_load_dwordx4 v18, s[16:19], s53 offen offset:1024  lds
  buffer_load_dwordx4 v19, s[16:19], s53 offen offset:2048  lds
  s_waitcnt lgkmcnt(0)
  buffer_load_dwordx4 v20, s[16:19], s53 offen offset:3072  lds
  s_waitcnt vmcnt(10)
  s_barrier
  v_mfma_f32_32x32x16_bf16 v[128:143], v[52:55], v[152:155], v[128:143]
  ds_read_b64_tr_b16 v[32:33], v22 offset:16384
  ds_read_b64_tr_b16 v[34:35], v22 offset:16896
  v_mfma_f32_32x32x16_bf16 v[64:79], v[40:43], v[152:155], v[64:79]
  ds_read_b64_tr_b16 v[36:37], v23 offset:16384
  ds_read_b64_tr_b16 v[38:39], v23 offset:16896
  v_mfma_f32_32x32x16_bf16 v[80:95], v[44:47], v[152:155], v[80:95]
  ds_read_b64_tr_b16 v[48:49], v21 offset:4096
  ds_read_b64_tr_b16 v[50:51], v21 offset:4352
  s_add_u32 s3, s3, 1
  s_cmp_eq_u32 s3, 7
  s_cselect_b32 s3, 0, s3
  v_mfma_f32_32x32x16_bf16 v[96:111], v[40:43], v[156:159], v[96:111]
  ds_read_b128 v[144:147], v12 offset:16384
  s_mul_i32 s53, s3, s48
  s_add_u32 m0, s92, 143360
  s_add_u32 s53, s53, s54
  v_mfma_f32_32x32x16_bf16 v[112:127], v[44:47], v[156:159], v[112:127]
  ds_read_b128 v[148:151], v252 offset:16384
  buffer_load_dwordx4 v16, s[12:15], s53 offen  lds
  s_lshl_b32 s53, s3, 7
  s_add_u32 m0, s93, 49152
  s_add_u32 s53, s53, s55
  s_waitcnt lgkmcnt(0)
  v_mfma_f32_32x32x16_bf16 v[128:143], v[48:51], v[144:147], v[128:143]
  ds_read_b64_tr_b16 v[40:41], v22 offset:18432
  ds_read_b64_tr_b16 v[42:43], v22 offset:18944
  v_mfma_f32_32x32x16_bf16 v[64:79], v[32:35], v[144:147], v[64:79]
  ds_read_b64_tr_b16 v[44:45], v23 offset:18432
  ds_read_b64_tr_b16 v[46:47], v23 offset:18944
  v_mfma_f32_32x32x16_bf16 v[80:95], v[36:39], v[144:147], v[80:95]
  ds_read_b64_tr_b16 v[52:53], v21 offset:5120
  ds_read_b64_tr_b16 v[54:55], v21 offset:5376
  buffer_load_dwordx4 v8, s[8:11], s53 offen offset:0  lds
  v_mfma_f32_32x32x16_bf16 v[96:111], v[32:35], v[148:151], v[96:111]
  ds_read_b128 v[152:155], v13 offset:16384
  buffer_load_dwordx4 v9, s[8:11], s53 offen offset:1024  lds
  v_mfma_f32_32x32x16_bf16 v[112:127], v[36:39], v[148:151], v[112:127]
  ds_read_b128 v[156:159], v253 offset:16384
  buffer_load_dwordx4 v10, s[8:11], s53 offen offset:2048  lds
  buffer_load_dwordx4 v11, s[8:11], s53 offen offset:3072  lds
  s_waitcnt lgkmcnt(0)
  v_mfma_f32_32x32x16_bf16 v[128:143], v[52:55], v[152:155], v[128:143]
  ds_read_b64_tr_b16 v[32:33], v22 offset:20480
  ds_read_b64_tr_b16 v[34:35], v22 offset:20992
  v_mfma_f32_32x32x16_bf16 v[64:79], v[40:43], v[152:155], v[64:79]
  ds_read_b64_tr_b16 v[36:37], v23 offset:20480
  ds_read_b64_tr_b16 v[38:39], v23 offset:20992
  v_mfma_f32_32x32x16_bf16 v[80:95], v[44:47], v[152:155], v[80:95]
  ds_read_b64_tr_b16 v[48:49], v21 offset:6144
  ds_read_b64_tr_b16 v[50:51], v21 offset:6400
  s_mul_i32 s53, s3, 229376
  s_add_u32 m0, s93, 114688
  s_add_u32 s53, s53, s51
  v_mfma_f32_32x32x16_bf16 v[96:111], v[40:43], v[156:159], v[96:111]
  ds_read_b128 v[144:147], v14 offset:16384
  buffer_load_dwordx4 v17, s[16:19], s53 offen offset:0  lds
  v_mfma_f32_32x32x16_bf16 v[112:127], v[44:47], v[156:159], v[112:127]
  ds_read_b128 v[148:151], v254 offset:16384
  buffer_load_dwordx4 v18, s[16:19], s53 offen offset:1024  lds
  buffer_load_dwordx4 v19, s[16:19], s53 offen offset:2048  lds
  s_waitcnt lgkmcnt(0)
  v_mfma_f32_32x32x16_bf16 v[128:143], v[48:51], v[144:147], v[128:143]
  ds_read_b64_tr_b16 v[40:41], v22 offset:22528
  ds_read_b64_tr_b16 v[42:43], v22 offset:23040
  v_mfma_f32_32x32x16_bf16 v[64:79], v[32:35], v[144:147], v[64:79]
  ds_read_b64_tr_b16 v[44:45], v23 offset:22528
  ds_read_b64_tr_b16 v[46:47], v23 offset:23040
  v_mfma_f32_32x32x16_bf16 v[80:95], v[36:39], v[144:147], v[80:95]
  ds_read_b64_tr_b16 v[52:53], v21 offset:7168
  ds_read_b64_tr_b16 v[54:55], v21 offset:7424
  buffer_load_dwordx4 v20, s[16:19], s53 offen offset:3072  lds
  v_mfma_f32_32x32x16_bf16 v[96:111], v[32:35], v[148:151], v[96:111]
  ds_read_b128 v[152:155], v15 offset:16384
  v_mfma_f32_32x32x16_bf16 v[112:127], v[36:39], v[148:151], v[112:127]
  ds_read_b128 v[156:159], v255 offset:16384
  s_waitcnt lgkmcnt(0)
  s_waitcnt vmcnt(9)
  s_barrier
  v_mfma_f32_32x32x16_bf16 v[128:143], v[52:55], v[152:155], v[128:143]
  ds_read_b64_tr_b16 v[32:33], v22 offset:32768
  ds_read_b64_tr_b16 v[34:35], v22 offset:33280
  v_mfma_f32_32x32x16_bf16 v[64:79], v[40:43], v[152:155], v[64:79]
  ds_read_b64_tr_b16 v[36:37], v23 offset:32768
  ds_read_b64_tr_b16 v[38:39], v23 offset:33280
  v_mfma_f32_32x32x16_bf16 v[80:95], v[44:47], v[152:155], v[80:95]
  ds_read_b64_tr_b16 v[48:49], v21 offset:8192
  ds_read_b64_tr_b16 v[50:51], v21 offset:8448
  s_add_u32 s3, s3, 1
  s_cmp_eq_u32 s3, 7
  s_cselect_b32 s3, 0, s3
  v_mfma_f32_32x32x16_bf16 v[96:111], v[40:43], v[156:159], v[96:111]
  ds_read_b128 v[144:147], v12 offset:32768
  s_mul_i32 s53, s3, s48
  s_add_u32 m0, s92, 131072
  s_add_u32 s53, s53, s54
  v_mfma_f32_32x32x16_bf16 v[112:127], v[44:47], v[156:159], v[112:127]
  ds_read_b128 v[148:151], v252 offset:32768
  buffer_load_dwordx4 v16, s[12:15], s53 offen  lds
  s_lshl_b32 s53, s3, 7
  s_add_u32 m0, s93, 0
  s_add_u32 s53, s53, s55
  s_waitcnt lgkmcnt(0)
  v_mfma_f32_32x32x16_bf16 v[128:143], v[48:51], v[144:147], v[128:143]
  ds_read_b64_tr_b16 v[40:41], v22 offset:34816
  ds_read_b64_tr_b16 v[42:43], v22 offset:35328
  v_mfma_f32_32x32x16_bf16 v[64:79], v[32:35], v[144:147], v[64:79]
  ds_read_b64_tr_b16 v[44:45], v23 offset:34816
  ds_read_b64_tr_b16 v[46:47], v23 offset:35328
  v_mfma_f32_32x32x16_bf16 v[80:95], v[36:39], v[144:147], v[80:95]
  ds_read_b64_tr_b16 v[52:53], v21 offset:9216
  ds_read_b64_tr_b16 v[54:55], v21 offset:9472
  buffer_load_dwordx4 v8, s[8:11], s53 offen offset:0  lds
  v_mfma_f32_32x32x16_bf16 v[96:111], v[32:35], v[148:151], v[96:111]
  ds_read_b128 v[152:155], v13 offset:32768
  buffer_load_dwordx4 v9, s[8:11], s53 offen offset:1024  lds
  v_mfma_f32_32x32x16_bf16 v[112:127], v[36:39], v[148:151], v[112:127]
  ds_read_b128 v[156:159], v253 offset:32768
  buffer_load_dwordx4 v10, s[8:11], s53 offen offset:2048  lds
  buffer_load_dwordx4 v11, s[8:11], s53 offen offset:3072  lds
  s_waitcnt lgkmcnt(0)
  v_mfma_f32_32x32x16_bf16 v[128:143], v[52:55], v[152:155], v[128:143]
  ds_read_b64_tr_b16 v[32:33], v22 offset:36864
  ds_read_b64_tr_b16 v[34:35], v22 offset:37376
  v_mfma_f32_32x32x16_bf16 v[64:79], v[40:43], v[152:155], v[64:79]
  ds_read_b64_tr_b16 v[36:37], v23 offset:36864
  ds_read_b64_tr_b16 v[38:39], v23 offset:37376
  v_mfma_f32_32x32x16_bf16 v[80:95], v[44:47], v[152:155], v[80:95]
  ds_read_b64_tr_b16 v[48:49], v21 offset:10240
  ds_read_b64_tr_b16 v[50:51], v21 offset:10496
  buffer_load_dword v28, v162, s[32:35], 0 offen sc1
  v_mfma_f32_32x32x16_bf16 v[96:111], v[40:43], v[156:159], v[96:111]
  ds_read_b128 v[144:147], v14 offset:32768
  s_mul_i32 s53, s3, 229376
  s_add_u32 m0, s93, 65536
  s_add_u32 s53, s53, s51
  v_mfma_f32_32x32x16_bf16 v[112:127], v[44:47], v[156:159], v[112:127]
  ds_read_b128 v[148:151], v254 offset:32768
  buffer_load_dwordx4 v17, s[16:19], s53 offen offset:0  lds
  buffer_load_dwordx4 v18, s[16:19], s53 offen offset:1024  lds
  s_waitcnt lgkmcnt(0)
  v_mfma_f32_32x32x16_bf16 v[128:143], v[48:51], v[144:147], v[128:143]
  ds_read_b64_tr_b16 v[40:41], v22 offset:38912
  ds_read_b64_tr_b16 v[42:43], v22 offset:39424
  v_mfma_f32_32x32x16_bf16 v[64:79], v[32:35], v[144:147], v[64:79]
  ds_read_b64_tr_b16 v[44:45], v23 offset:38912
  ds_read_b64_tr_b16 v[46:47], v23 offset:39424
  v_mfma_f32_32x32x16_bf16 v[80:95], v[36:39], v[144:147], v[80:95]
  ds_read_b64_tr_b16 v[52:53], v21 offset:11264
  ds_read_b64_tr_b16 v[54:55], v21 offset:11520
  buffer_load_dwordx4 v19, s[16:19], s53 offen offset:2048  lds
  v_mfma_f32_32x32x16_bf16 v[96:111], v[32:35], v[148:151], v[96:111]
  ds_read_b128 v[152:155], v15 offset:32768
  buffer_load_dwordx4 v20, s[16:19], s53 offen offset:3072  lds
  v_mfma_f32_32x32x16_bf16 v[112:127], v[36:39], v[148:151], v[112:127]
  ds_read_b128 v[156:159], v255 offset:32768
  s_mov_b32 s4, s42
  s_and_b32 s5, s43, 0xffff
  s_mov_b32 s6, 1605632
  s_mov_b32 s7, 0x20000
  s_waitcnt lgkmcnt(0)
  s_and_b32 s52, s44, 3
  s_lshl2_add_u32 s52, s65, s52
  s_mul_i32 s52, s52, 3
  s_add_u32 s52, s52, s46
  s_sub_u32 s52, s52, 13
  s_lshr_b32 s53, s44, 2
  s_lshl2_add_u32 s52, s52, s53
  s_lshl1_add_u32 s52, s52, s64
  s_mul_i32 s53, s52, 2432
  s_mul_i32 s52, s52, 640
  s_cmp_eq_u32 s46, 0
  s_cselect_b32 s53, 0x4000000, s53
  s_cselect_b32 s52, 0x4000000, s52
  v_lshlrev_b32 v7, 7, v1
  v_mov_b32 v5, 0x4000000
  v_cmp_gt_u32 vcc, 19, v1
  v_add_u32 v3, s53, v7
  v_add_u32 v4, s52, v7
  v_cndmask_b32 v3, v5, v3, vcc
  v_cmp_gt_u32 vcc, 5, v1
  s_mov_b32 s52, 2432
  s_mov_b32 s53, 4864
  v_cndmask_b32 v4, v5, v4, vcc
  buffer_load_dword v251, v3, s[4:7], 0 offen
  buffer_load_dword v251, v4, s[24:27], 0 offen
  s_waitcnt vmcnt(12)
  s_barrier
  v_mfma_f32_32x32x16_bf16 v[128:143], v[52:55], v[152:155], v[128:143]
  ds_read_b64_tr_b16 v[32:33], v22 offset:49152
  ds_read_b64_tr_b16 v[34:35], v22 offset:49664
  v_mfma_f32_32x32x16_bf16 v[64:79], v[40:43], v[152:155], v[64:79]
  ds_read_b64_tr_b16 v[36:37], v23 offset:49152
  ds_read_b64_tr_b16 v[38:39], v23 offset:49664
  v_mfma_f32_32x32x16_bf16 v[80:95], v[44:47], v[152:155], v[80:95]
  ds_read_b64_tr_b16 v[48:49], v21 offset:12288
  ds_read_b64_tr_b16 v[50:51], v21 offset:12544
  s_add_u32 s3, s3, 1
  s_cmp_eq_u32 s3, 7
  s_cselect_b32 s3, 0, s3
  v_mfma_f32_32x32x16_bf16 v[96:111], v[40:43], v[156:159], v[96:111]
  ds_read_b128 v[144:147], v12 offset:49152
  s_mul_i32 s53, s3, s48
  s_add_u32 m0, s92, 135168
  s_add_u32 s53, s53, s54
  v_mfma_f32_32x32x16_bf16 v[112:127], v[44:47], v[156:159], v[112:127]
  ds_read_b128 v[148:151], v252 offset:49152
  buffer_load_dwordx4 v16, s[12:15], s53 offen  lds
  s_lshl_b32 s53, s3, 7
  s_add_u32 m0, s93, 16384
  s_add_u32 s53, s53, s55
  s_waitcnt lgkmcnt(0)
  v_mfma_f32_32x32x16_bf16 v[128:143], v[48:51], v[144:147], v[128:143]
  ds_read_b64_tr_b16 v[40:41], v22 offset:51200
  ds_read_b64_tr_b16 v[42:43], v22 offset:51712
  v_mfma_f32_32x32x16_bf16 v[64:79], v[32:35], v[144:147], v[64:79]
  ds_read_b64_tr_b16 v[44:45], v23 offset:51200
  ds_read_b64_tr_b16 v[46:47], v23 offset:51712
  v_mfma_f32_32x32x16_bf16 v[80:95], v[36:39], v[144:147], v[80:95]
  ds_read_b64_tr_b16 v[52:53], v21 offset:13312
  ds_read_b64_tr_b16 v[54:55], v21 offset:13568
  buffer_load_dwordx4 v8, s[8:11], s53 offen offset:0  lds
  v_mfma_f32_32x32x16_bf16 v[96:111], v[32:35], v[148:151], v[96:111]
  ds_read_b128 v[152:155], v13 offset:49152
  buffer_load_dwordx4 v9, s[8:11], s53 offen offset:1024  lds
  v_mfma_f32_32x32x16_bf16 v[112:127], v[36:39], v[148:151], v[112:127]
  ds_read_b128 v[156:159], v253 offset:49152
  buffer_load_dwordx4 v10, s[8:11], s53 offen offset:2048  lds
  buffer_load_dwordx4 v11, s[8:11], s53 offen offset:3072  lds
  s_waitcnt lgkmcnt(0)
  v_mfma_f32_32x32x16_bf16 v[128:143], v[52:55], v[152:155], v[128:143]
  ds_read_b64_tr_b16 v[32:33], v22 offset:53248
  ds_read_b64_tr_b16 v[34:35], v22 offset:53760
  v_mfma_f32_32x32x16_bf16 v[64:79], v[40:43], v[152:155], v[64:79]
  ds_read_b64_tr_b16 v[36:37], v23 offset:53248
  ds_read_b64_tr_b16 v[38:39], v23 offset:53760
  v_mfma_f32_32x32x16_bf16 v[80:95], v[44:47], v[152:155], v[80:95]
  ds_read_b64_tr_b16 v[48:49], v21 offset:14336
  ds_read_b64_tr_b16 v[50:51], v21 offset:14592
  s_mul_i32 s53, s3, 229376
  s_add_u32 m0, s93, 81920
  s_add_u32 s53, s53, s51
  v_mfma_f32_32x32x16_bf16 v[96:111], v[40:43], v[156:159], v[96:111]
  ds_read_b128 v[144:147], v14 offset:49152
  buffer_load_dwordx4 v17, s[16:19], s53 offen offset:0  lds
  v_mfma_f32_32x32x16_bf16 v[112:127], v[44:47], v[156:159], v[112:127]
  ds_read_b128 v[148:151], v254 offset:49152
  buffer_load_dwordx4 v18, s[16:19], s53 offen offset:1024  lds
  buffer_load_dwordx4 v19, s[16:19], s53 offen offset:2048  lds
  s_waitcnt lgkmcnt(0)
  v_mfma_f32_32x32x16_bf16 v[128:143], v[48:51], v[144:147], v[128:143]
  ds_read_b64_tr_b16 v[40:41], v22 offset:55296
  ds_read_b64_tr_b16 v[42:43], v22 offset:55808
  v_mfma_f32_32x32x16_bf16 v[64:79], v[32:35], v[144:147], v[64:79]
  ds_read_b64_tr_b16 v[44:45], v23 offset:55296
  ds_read_b64_tr_b16 v[46:47], v23 offset:55808
  v_mfma_f32_32x32x16_bf16 v[80:95], v[36:39], v[144:147], v[80:95]
  ds_read_b64_tr_b16 v[52:53], v21 offset:15360
  ds_read_b64_tr_b16 v[54:55], v21 offset:15616
  buffer_load_dwordx4 v20, s[16:19], s53 offen offset:3072  lds
  v_mfma_f32_32x32x16_bf16 v[96:111], v[32:35], v[148:151], v[96:111]
  ds_read_b128 v[152:155], v15 offset:49152
  v_mfma_f32_32x32x16_bf16 v[112:127], v[36:39], v[148:151], v[112:127]
  ds_read_b128 v[156:159], v255 offset:49152
  s_waitcnt lgkmcnt(0)
  s_waitcnt vmcnt(11)
  s_barrier
  v_mfma_f32_32x32x16_bf16 v[128:143], v[52:55], v[152:155], v[128:143]
  ds_read_b64_tr_b16 v[32:33], v22 offset:0
  ds_read_b64_tr_b16 v[34:35], v22 offset:512
  v_mfma_f32_32x32x16_bf16 v[64:79], v[40:43], v[152:155], v[64:79]
  ds_read_b64_tr_b16 v[36:37], v23 offset:0
  ds_read_b64_tr_b16 v[38:39], v23 offset:512
  v_mfma_f32_32x32x16_bf16 v[80:95], v[44:47], v[152:155], v[80:95]
  ds_read_b64_tr_b16 v[48:49], v21 offset:0
  ds_read_b64_tr_b16 v[50:51], v21 offset:256
  s_add_u32 s3, s3, 1
  s_cmp_eq_u32 s3, 7
  s_cselect_b32 s3, 0, s3
  v_mfma_f32_32x32x16_bf16 v[96:111], v[40:43], v[156:159], v[96:111]
  ds_read_b128 v[144:147], v12 offset:0
  s_mul_i32 s53, s3, s48
  s_add_u32 m0, s92, 139264
  s_add_u32 s53, s53, s54
  v_mfma_f32_32x32x16_bf16 v[112:127], v[44:47], v[156:159], v[112:127]
  ds_read_b128 v[148:151], v252 offset:0
  buffer_load_dwordx4 v16, s[12:15], s53 offen  lds
  s_lshl_b32 s53, s3, 7
  s_add_u32 m0, s93, 32768
  s_add_u32 s53, s53, s55
  s_waitcnt lgkmcnt(0)
  v_mfma_f32_32x32x16_bf16 v[128:143], v[48:51], v[144:147], v[128:143]
  ds_read_b64_tr_b16 v[40:41], v22 offset:2048
  ds_read_b64_tr_b16 v[42:43], v22 offset:2560
  v_mfma_f32_32x32x16_bf16 v[64:79], v[32:35], v[144:147], v[64:79]
  ds_read_b64_tr_b16 v[44:45], v23 offset:2048
  ds_read_b64_tr_b16 v[46:47], v23 offset:2560
  v_mfma_f32_32x32x16_bf16 v[80:95], v[36:39], v[144:147], v[80:95]
  ds_read_b64_tr_b16 v[52:53], v21 offset:1024
  ds_read_b64_tr_b16 v[54:55], v21 offset:1280
  buffer_load_dwordx4 v8, s[8:11], s53 offen offset:0  lds
  v_mfma_f32_32x32x16_bf16 v[96:111], v[32:35], v[148:151], v[96:111]
  ds_read_b128 v[152:155], v13 offset:0
  buffer_load_dwordx4 v9, s[8:11], s53 offen offset:1024  lds
  v_mfma_f32_32x32x16_bf16 v[112:127], v[36:39], v[148:151], v[112:127]
  ds_read_b128 v[156:159], v253 offset:0
  buffer_load_dwordx4 v10, s[8:11], s53 offen offset:2048  lds
  buffer_load_dwordx4 v11, s[8:11], s53 offen offset:3072  lds
  s_waitcnt lgkmcnt(0)
  v_mfma_f32_32x32x16_bf16 v[128:143], v[52:55], v[152:155], v[128:143]
  ds_read_b64_tr_b16 v[32:33], v22 offset:4096
  ds_read_b64_tr_b16 v[34:35], v22 offset:4608
  v_mfma_f32_32x32x16_bf16 v[64:79], v[40:43], v[152:155], v[64:79]
  ds_read_b64_tr_b16 v[36:37], v23 offset:4096
  ds_read_b64_tr_b16 v[38:39], v23 offset:4608
  v_mfma_f32_32x32x16_bf16 v[80:95], v[44:47], v[152:155], v[80:95]
  ds_read_b64_tr_b16 v[48:49], v21 offset:2048
  ds_read_b64_tr_b16 v[50:51], v21 offset:2304
  s_mul_i32 s53, s3, 229376
  s_add_u32 m0, s93, 98304
  s_add_u32 s53, s53, s51
  v_mfma_f32_32x32x16_bf16 v[96:111], v[40:43], v[156:159], v[96:111]
  ds_read_b128 v[144:147], v14 offset:0
  buffer_load_dwordx4 v17, s[16:19], s53 offen offset:0  lds
  v_mfma_f32_32x32x16_bf16 v[112:127], v[44:47], v[156:159], v[112:127]
  ds_read_b128 v[148:151], v254 offset:0
  buffer_load_dwordx4 v18, s[16:19], s53 offen offset:1024  lds
  buffer_load_dwordx4 v19, s[16:19], s53 offen offset:2048  lds
  s_waitcnt lgkmcnt(0)
  v_mfma_f32_32x32x16_bf16 v[128:143], v[48:51], v[144:147], v[128:143]
  ds_read_b64_tr_b16 v[40:41], v22 offset:6144
  ds_read_b64_tr_b16 v[42:43], v22 offset:6656
  v_mfma_f32_32x32x16_bf16 v[64:79], v[32:35], v[144:147], v[64:79]
  ds_read_b64_tr_b16 v[44:45], v23 offset:6144
  ds_read_b64_tr_b16 v[46:47], v23 offset:6656
  v_mfma_f32_32x32x16_bf16 v[80:95], v[36:39], v[144:147], v[80:95]
  ds_read_b64_tr_b16 v[52:53], v21 offset:3072
  ds_read_b64_tr_b16 v[54:55], v21 offset:3328
  buffer_load_dwordx4 v20, s[16:19], s53 offen offset:3072  lds
  v_mfma_f32_32x32x16_bf16 v[96:111], v[32:35], v[148:151], v[96:111]
  ds_read_b128 v[152:155], v15 offset:0
  s_lshl4_add_u32 s50, s46, s45
  s_lshl_b32 s50, s50, 11
  s_add_u32 s50, s50, 458752
  s_add_u32 s50, s50, s2
  v_mfma_f32_32x32x16_bf16 v[112:127], v[36:39], v[148:151], v[112:127]
  ds_read_b128 v[156:159], v255 offset:0
  v_mov_b32 v164, -1
  v_mov_b32 v165, -1
  v_mov_b32 v166, -1
  v_mov_b32 v167, -1
  buffer_store_dwordx4 v[164:167], v2, s[20:23], s50 offen offset:0 sc1
  s_waitcnt lgkmcnt(0)
  buffer_store_dwordx4 v[164:167], v2, s[20:23], s50 offen offset:1024 sc1
  s_waitcnt vmcnt(11)
  s_cmp_lg_u32 s46, 0
  s_cbranch_scc1 L_ok0
  v_readfirstlane_b32 s52, v28
  s_cmp_ge_u32 s52, 16
  s_cbranch_scc0 L_sp0
L_ok0:
  s_barrier
  v_mfma_f32_32x32x16_bf16 v[128:143], v[52:55], v[152:155], v[128:143]
  ds_read_b64_tr_b16 v[32:33], v22 offset:16384
  ds_read_b64_tr_b16 v[34:35], v22 offset:16896
  v_mfma_f32_32x32x16_bf16 v[64:79], v[40:43], v[152:155], v[64:79]
  ds_read_b64_tr_b16 v[36:37], v23 offset:16384
  ds_read_b64_tr_b16 v[38:39], v23 offset:16896
  v_mfma_f32_32x32x16_bf16 v[80:95], v[44:47], v[152:155], v[80:95]
  ds_read_b64_tr_b16 v[48:49], v21 offset:4096
  ds_read_b64_tr_b16 v[50:51], v21 offset:4352
  v_mfma_f32_32x32x16_bf16 v[96:111], v[40:43], v[156:159], v[96:111]
  ds_read_b128 v[144:147], v12 offset:16384
  v_mfma_f32_32x32x16_bf16 v[112:127], v[44:47], v[156:159], v[112:127]
  ds_read_b128 v[148:151], v252 offset:16384
  s_waitcnt lgkmcnt(0)
  v_mfma_f32_32x32x16_bf16 v[128:143], v[48:51], v[144:147], v[128:143]
  ds_read_b64_tr_b16 v[40:41], v22 offset:18432
  ds_read_b64_tr_b16 v[42:43], v22 offset:18944
  v_mfma_f32_32x32x16_bf16 v[64:79], v[32:35], v[144:147], v[64:79]
  ds_read_b64_tr_b16 v[44:45], v23 offset:18432
  ds_read_b64_tr_b16 v[46:47], v23 offset:18944
  v_mfma_f32_32x32x16_bf16 v[80:95], v[36:39], v[144:147], v[80:95]
  ds_read_b64_tr_b16 v[52:53], v21 offset:5120
  ds_read_b64_tr_b16 v[54:55], v21 offset:5376
  v_mfma_f32_32x32x16_bf16 v[96:111], v[32:35], v[148:151], v[96:111]
  ds_read_b128 v[152:155], v13 offset:16384
  v_mfma_f32_32x32x16_bf16 v[112:127], v[36:39], v[148:151], v[112:127]
  ds_read_b128 v[156:159], v253 offset:16384
  s_waitcnt lgkmcnt(0)
  v_mfma_f32_32x32x16_bf16 v[128:143], v[52:55], v[152:155], v[128:143]
  ds_read_b64_tr_b16 v[32:33], v22 offset:20480
  ds_read_b64_tr_b16 v[34:35], v22 offset:20992
  v_mfma_f32_32x32x16_bf16 v[64:79], v[40:43], v[152:155], v[64:79]
  ds_read_b64_tr_b16 v[36:37], v23 offset:20480
  ds_read_b64_tr_b16 v[38:39], v23 offset:20992
  v_mfma_f32_32x32x16_bf16 v[80:95], v[44:47], v[152:155], v[80:95]
  ds_read_b64_tr_b16 v[48:49], v21 offset:6144
  ds_read_b64_tr_b16 v[50:51], v21 offset:6400
  buffer_load_dword v28, v160, s[20:23], 0 offen sc1
  v_mfma_f32_32x32x16_bf16 v[96:111], v[40:43], v[156:159], v[96:111]
  ds_read_b128 v[144:147], v14 offset:16384
  v_mfma_f32_32x32x16_bf16 v[112:127], v[44:47], v[156:159], v[112:127]
  ds_read_b128 v[148:151], v254 offset:16384
  s_waitcnt lgkmcnt(0)
  v_mfma_f32_32x32x16_bf16 v[128:143], v[48:51], v[144:147], v[128:143]
  ds_read_b64_tr_b16 v[40:41], v22 offset:22528
  ds_read_b64_tr_b16 v[42:43], v22 offset:23040
  v_mfma_f32_32x32x16_bf16 v[64:79], v[32:35], v[144:147], v[64:79]
  ds_read_b64_tr_b16 v[44:45], v23 offset:22528
  ds_read_b64_tr_b16 v[46:47], v23 offset:23040
  v_mfma_f32_32x32x16_bf16 v[80:95], v[36:39], v[144:147], v[80:95]
  ds_read_b64_tr_b16 v[52:53], v21 offset:7168
  ds_read_b64_tr_b16 v[54:55], v21 offset:7424
  v_mfma_f32_32x32x16_bf16 v[96:111], v[32:35], v[148:151], v[96:111]
  ds_read_b128 v[152:155], v15 offset:16384
  v_mfma_f32_32x32x16_bf16 v[112:127], v[36:39], v[148:151], v[112:127]
  ds_read_b128 v[156:159], v255 offset:16384
  s_waitcnt lgkmcnt(0)
  s_waitcnt vmcnt(3)
  s_barrier
  v_mfma_f32_32x32x16_bf16 v[128:143], v[52:55], v[152:155], v[128:143]
  ds_read_b64_tr_b16 v[32:33], v22 offset:32768
  ds_read_b64_tr_b16 v[34:35], v22 offset:33280
  v_mfma_f32_32x32x16_bf16 v[64:79], v[40:43], v[152:155], v[64:79]
  ds_read_b64_tr_b16 v[36:37], v23 offset:32768
  ds_read_b64_tr_b16 v[38:39], v23 offset:33280
  v_mfma_f32_32x32x16_bf16 v[80:95], v[44:47], v[152:155], v[80:95]
  ds_read_b64_tr_b16 v[48:49], v21 offset:8192
  ds_read_b64_tr_b16 v[50:51], v21 offset:8448
  v_mfma_f32_32x32x16_bf16 v[96:111], v[40:43], v[156:159], v[96:111]
  ds_read_b128 v[144:147], v12 offset:32768
  v_mfma_f32_32x32x16_bf16 v[112:127], v[44:47], v[156:159], v[112:127]
  ds_read_b128 v[148:151], v252 offset:32768
  s_waitcnt lgkmcnt(0)
  s_waitcnt vmcnt(0)
  v_cmp_eq_u32 vcc, 1, v28
  s_cmp_eq_u64 vcc, -1
  s_cbranch_scc0 L_sp1
L_ok1:
  v_mfma_f32_32x32x16_bf16 v[128:143], v[48:51], v[144:147], v[128:143]
  ds_read_b64_tr_b16 v[40:41], v22 offset:34816
  ds_read_b64_tr_b16 v[42:43], v22 offset:35328
  global_load_dwordx4 v[232:235], v2, s[98:99] offset:0 sc1
  v_mfma_f32_32x32x16_bf16 v[64:79], v[32:35], v[144:147], v[64:79]
  ds_read_b64_tr_b16 v[44:45], v23 offset:34816
  ds_read_b64_tr_b16 v[46:47], v23 offset:35328
  global_load_dwordx4 v[236:239], v2, s[98:99] offset:1024 sc1
  v_mfma_f32_32x32x16_bf16 v[80:95], v[36:39], v[144:147], v[80:95]
  ds_read_b64_tr_b16 v[52:53], v21 offset:9216
  ds_read_b64_tr_b16 v[54:55], v21 offset:9472
  s_lshl_b32 s53, s46, 16
  v_mfma_f32_32x32x16_bf16 v[96:111], v[32:35], v[148:151], v[96:111]
  ds_read_b128 v[152:155], v13 offset:32768
  s_add_u32 s53, s53, 4096
  v_mfma_f32_32x32x16_bf16 v[112:127], v[36:39], v[148:151], v[112:127]
  ds_read_b128 v[156:159], v253 offset:32768
  s_add_u32 s36, s98, s53
  s_addc_u32 s37, s99, 0
  s_waitcnt lgkmcnt(0)
  v_mfma_f32_32x32x16_bf16 v[128:143], v[52:55], v[152:155], v[128:143]
  ds_read_b64_tr_b16 v[32:33], v22 offset:36864
  ds_read_b64_tr_b16 v[34:35], v22 offset:37376
  global_load_dwordx4 v[168:171], v2, s[36:37] offset:-4096 sc1
  v_mfma_f32_32x32x16_bf16 v[64:79], v[40:43], v[152:155], v[64:79]
  ds_read_b64_tr_b16 v[36:37], v23 offset:36864
  ds_read_b64_tr_b16 v[38:39], v23 offset:37376
  global_load_dwordx4 v[172:175], v2, s[36:37] offset:-3072 sc1
  v_mfma_f32_32x32x16_bf16 v[80:95], v[44:47], v[152:155], v[80:95]
  ds_read_b64_tr_b16 v[48:49], v21 offset:10240
  ds_read_b64_tr_b16 v[50:51], v21 offset:10496
  global_load_dwordx4 v[176:179], v2, s[36:37] offset:-2048 sc1
  v_mfma_f32_32x32x16_bf16 v[96:111], v[40:43], v[156:159], v[96:111]
  ds_read_b128 v[144:147], v14 offset:32768
  global_load_dwordx4 v[180:183], v2, s[36:37] offset:-1024 sc1
  v_mfma_f32_32x32x16_bf16 v[112:127], v[44:47], v[156:159], v[112:127]
  ds_read_b128 v[148:151], v254 offset:32768
  global_load_dwordx4 v[184:187], v2, s[36:37] offset:0 sc1
  global_load_dwordx4 v[188:191], v2, s[36:37] offset:1024 sc1
  s_waitcnt lgkmcnt(0)
  v_mfma_f32_32x32x16_bf16 v[128:143], v[48:51], v[144:147], v[128:143]
  ds_read_b64_tr_b16 v[40:41], v22 offset:38912
  ds_read_b64_tr_b16 v[42:43], v22 offset:39424
  global_load_dwordx4 v[192:195], v2, s[36:37] offset:2048 sc1
  v_mfma_f32_32x32x16_bf16 v[64:79], v[32:35], v[144:147], v[64:79]
  ds_read_b64_tr_b16 v[44:45], v23 offset:38912
  ds_read_b64_tr_b16 v[46:47], v23 offset:39424
  global_load_dwordx4 v[196:199], v2, s[36:37] offset:3072 sc1
  v_mfma_f32_32x32x16_bf16 v[80:95], v[36:39], v[144:147], v[80:95]
  ds_read_b64_tr_b16 v[52:53], v21 offset:11264
  ds_read_b64_tr_b16 v[54:55], v21 offset:11520
  s_add_u32 s36, s36, 8192
  v_mfma_f32_32x32x16_bf16 v[96:111], v[32:35], v[148:151], v[96:111]
  ds_read_b128 v[152:155], v15 offset:32768
  s_addc_u32 s37, s37, 0
  v_mfma_f32_32x32x16_bf16 v[112:127], v[36:39], v[148:151], v[112:127]
  ds_read_b128 v[156:159], v255 offset:32768
  global_load_dwordx4 v[200:203], v2, s[36:37] offset:-4096 sc1
  global_load_dwordx4 v[204:207], v2, s[36:37] offset:-3072 sc1
  s_waitcnt lgkmcnt(0)
  v_mfma_f32_32x32x16_bf16 v[128:143], v[52:55], v[152:155], v[128:143]
  global_load_dwordx4 v[208:211], v2, s[36:37] offset:-2048 sc1
  v_mfma_f32_32x32x16_bf16 v[64:79], v[40:43], v[152:155], v[64:79]
  global_load_dwordx4 v[212:215], v2, s[36:37] offset:-1024 sc1
  v_mfma_f32_32x32x16_bf16 v[80:95], v[44:47], v[152:155], v[80:95]
  v_mfma_f32_32x32x16_bf16 v[96:111], v[40:43], v[156:159], v[96:111]
  v_mfma_f32_32x32x16_bf16 v[112:127], v[44:47], v[156:159], v[112:127]
L_join:
  s_mul_i32 s52, s46, 114688
  s_lshl_b32 s53, s68, 12
  s_add_u32 s52, s52, s53
  s_add_u32 s52, s52, s2
  s_bitcmp0_b32 s46, 0
  s_cselect_b32 s53, 1, -1
  s_mul_i32 s53, s53, 114688
  s_add_u32 s53, s53, s52
  s_cmp_eq_u32 s59, 1
  s_cselect_b32 s52, 33554432, s52
  s_cselect_b32 s53, 33554432, s53
  s_mov_b32 s54, 0x3e8b97f6
  s_lshl_b32 s68, s46, 15
  s_lshl_b32 s69, s45, 11
  s_add_u32 s68, s68, s69
  s_add_u32 s68, s68, 458752
  s_add_u32 s68, s68, s2
  s_mov_b32 s50, s68
  s_mov_b32 s48, s52
  s_mov_b32 s51, s53
  v_pk_mul_f32 v[128:129], v[128:129], s[54:55] op_sel_hi:[1,0]
  v_pk_mul_f32 v[130:131], v[130:131], s[54:55] op_sel_hi:[1,0]
  v_pk_mul_f32 v[132:133], v[132:133], s[54:55] op_sel_hi:[1,0]
  v_pk_mul_f32 v[134:135], v[134:135], s[54:55] op_sel_hi:[1,0]
  v_pk_mul_f32 v[136:137], v[136:137], s[54:55] op_sel_hi:[1,0]
  v_pk_mul_f32 v[138:139], v[138:139], s[54:55] op_sel_hi:[1,0]
  v_pk_mul_f32 v[140:141], v[140:141], s[54:55] op_sel_hi:[1,0]
  v_pk_mul_f32 v[142:143], v[142:143], s[54:55] op_sel_hi:[1,0]
  v_cvt_pk_bf16_f32 v32, v128, v129
  v_cvt_pk_bf16_f32 v33, v130, v131
  v_cvt_pk_bf16_f32 v34, v132, v133
  v_cvt_pk_bf16_f32 v35, v134, v135
  v_cvt_pk_bf16_f32 v36, v136, v137
  v_cvt_pk_bf16_f32 v37, v138, v139
  v_cvt_pk_bf16_f32 v38, v140, v141
  v_cvt_pk_bf16_f32 v39, v142, v143
  v_cndmask_b32 v38, v38, 0, s[66:67]
  v_cndmask_b32 v39, v39, 0, s[66:67]
  v_cvt_pk_bf16_f32 v40, v64, v65
  v_cvt_pk_bf16_f32 v41, v66, v67
  v_cvt_pk_bf16_f32 v42, v68, v69
  v_cvt_pk_bf16_f32 v43, v70, v71
  v_cvt_pk_bf16_f32 v44, v72, v73
  v_cvt_pk_bf16_f32 v45, v74, v75
  v_cvt_pk_bf16_f32 v46, v76, v77
  v_cvt_pk_bf16_f32 v47, v78, v79
  v_pk_max_i16 v40, v40, 0
  v_pk_max_i16 v41, v41, 0
  v_pk_max_i16 v42, v42, 0
  v_pk_max_i16 v43, v43, 0
  v_pk_max_i16 v44, v44, 0
  v_pk_max_i16 v45, v45, 0
  v_pk_max_i16 v46, v46, 0
  v_pk_max_i16 v47, v47, 0
  buffer_store_dwordx4 v[40:43], v2, s[20:23], s52 offen offset:0 sc1
  buffer_store_dwordx4 v[44:47], v2, s[20:23], s52 offen offset:1024 sc1
  s_waitcnt vmcnt(14)
  v_mfma_f32_32x32x16_bf16 v[144:159], v[232:235], v[32:35], 0
  v_mfma_f32_32x32x16_bf16 v[144:159], v[236:239], v[36:39], v[144:159]
  v_cvt_pk_bf16_f32 v8, v80, v81
  v_cvt_pk_bf16_f32 v9, v82, v83
  v_cvt_pk_bf16_f32 v10, v84, v85
  v_cvt_pk_bf16_f32 v11, v86, v87
  v_cvt_pk_bf16_f32 v12, v88, v89
  v_cvt_pk_bf16_f32 v13, v90, v91
  v_cvt_pk_bf16_f32 v14, v92, v93
  v_cvt_pk_bf16_f32 v15, v94, v95
  v_pk_max_i16 v8, v8, 0
  v_pk_max_i16 v9, v9, 0
  v_pk_max_i16 v10, v10, 0
  v_pk_max_i16 v11, v11, 0
  v_pk_max_i16 v12, v12, 0
  v_pk_max_i16 v13, v13, 0
  v_pk_max_i16 v14, v14, 0
  v_pk_max_i16 v15, v15, 0
  s_lshl_b32 s52, s46, 11
  s_add_u32 s52, s52, 147456
  v_add_u32 v6, s52, v2
  v_max3_f32 v5, v144, v145, v146
  v_max3_f32 v5, v5, v147, v148
  v_max3_f32 v5, v5, v149, v150
  v_max3_f32 v5, v5, v151, v152
  v_max3_f32 v5, v5, v153, v154
  v_max3_f32 v5, v5, v155, v156
  v_max3_f32 v5, v5, v157, v158
  v_max_f32 v5, v5, v159
  v_mov_b32 v3, v5
  s_nop 1
  v_permlane32_swap_b32 v3, v5
  s_nop 1
  v_max_f32 v5, v5, v3
  v_sub_f32 v5, 0, v5
  v_and_b32 v3, 0xffff0000, v5
  v_sub_f32 v5, v5, v3
  v_and_b32 v4, 0xffff0000, v5
  v_sub_f32 v5, v5, v4
  v_lshrrev_b32 v3, 16, v3
  v_or_b32 v3, v3, v4
  v_lshrrev_b32 v5, 16, v5
  v_cndmask_b32 v38, v38, v3, s[66:67]
  v_cndmask_b32 v39, v39, v5, s[66:67]
  ds_write_b128 v6, v[32:35]
  ds_write_b128 v6, v[36:39] offset:1024
  v_cvt_pk_bf16_f32 v16, v96, v97
  v_cvt_pk_bf16_f32 v17, v98, v99
  v_cvt_pk_bf16_f32 v18, v100, v101
  v_cvt_pk_bf16_f32 v19, v102, v103
  v_cvt_pk_bf16_f32 v20, v104, v105
  v_cvt_pk_bf16_f32 v21, v106, v107
  v_cvt_pk_bf16_f32 v22, v108, v109
  v_cvt_pk_bf16_f32 v23, v110, v111
  v_pk_max_i16 v16, v16, 0
  v_pk_max_i16 v17, v17, 0
  v_pk_max_i16 v18, v18, 0
  v_pk_max_i16 v19, v19, 0
  v_pk_max_i16 v20, v20, 0
  v_pk_max_i16 v21, v21, 0
  v_pk_max_i16 v22, v22, 0
  v_pk_max_i16 v23, v23, 0
  v_cvt_pk_bf16_f32 v232, v112, v113
  v_cvt_pk_bf16_f32 v233, v114, v115
  v_cvt_pk_bf16_f32 v234, v116, v117
  v_cvt_pk_bf16_f32 v235, v118, v119
  v_cvt_pk_bf16_f32 v236, v120, v121
  v_cvt_pk_bf16_f32 v237, v122, v123
  v_cvt_pk_bf16_f32 v238, v124, v125
  v_cvt_pk_bf16_f32 v239, v126, v127
  v_pk_max_i16 v232, v232, 0
  v_pk_max_i16 v233, v233, 0
  v_pk_max_i16 v234, v234, 0
  v_pk_max_i16 v235, v235, 0
  v_pk_max_i16 v236, v236, 0
  v_pk_max_i16 v237, v237, 0
  v_pk_max_i16 v238, v238, 0
  v_pk_max_i16 v239, v239, 0
  s_add_u32 s52, s46, 1
  s_and_b32 s52, s52, 3
  s_lshl_b32 s52, s52, 11
  s_add_u32 s52, s52, 147456
  v_add_u32 v4, s52, v2
  s_add_u32 s52, s46, 2
  s_and_b32 s52, s52, 3
  s_lshl_b32 s52, s52, 11
  s_add_u32 s52, s52, 147456
  v_add_u32 v5, s52, v2
  s_add_u32 s52, s46, 3
  s_and_b32 s52, s52, 3
  s_lshl_b32 s52, s52, 11
  s_add_u32 s52, s52, 147456
  v_add_u32 v6, s52, v2
  s_waitcnt lgkmcnt(0)
  s_barrier
  ds_read_b128 v[40:43], v4 offset:0
  ds_read_b128 v[44:47], v4 offset:1024
  ds_read_b128 v[48:51], v5 offset:0
  ds_read_b128 v[52:55], v5 offset:1024
  ds_read_b128 v[56:59], v6 offset:0
  ds_read_b128 v[60:63], v6 offset:1024
L_attn:
  s_add_u32 s4, s98, s60
  s_addc_u32 s5, s99, 0
  s_add_u32 s6, s42, s61
  s_addc_u32 s7, s43, 0
  s_waitcnt vmcnt(10)
  v_mfma_f32_32x32x16_bf16 v[128:143], v[168:171], v[32:35], 0
  v_mfma_f32_32x32x16_bf16 v[128:143], v[172:175], v[36:39], v[128:143]
  v_and_b32 v4, 31, v1
  v_lshlrev_b32 v4, 2, v4
  v_mul_u32_u24 v5, 896, v1
  s_lshr_b32 s52, s46, 1
  s_lshl_b32 s52, s52, 7
  v_xor_b32 v3, s52, v4
  v_xor_b32 v6, 0x80, v3
  s_waitcnt lgkmcnt(0)
  s_nop 3
  v_mfma_f32_32x32x16_bf16 v[144:159], v[168:171], v[40:43], 0
  buffer_store_dwordx4 v[8:11], v2, s[20:23], s48 offen offset:2048 sc1
  v_exp_f32 v128, v128
  v_exp_f32 v129, v129
  v_exp_f32 v130, v130
  v_exp_f32 v131, v131
  v_cvt_pk_bf16_f32 v160, v128, v129
  v_cvt_pk_bf16_f32 v161, v130, v131
  v_mfma_f32_32x32x16_bf16 v[144:159], v[172:175], v[44:47], v[144:159]
  s_add_u32 s52, s46, 1
  s_and_b32 s52, s52, 3
  v_exp_f32 v132, v132
  v_exp_f32 v133, v133
  v_exp_f32 v134, v134
  v_exp_f32 v135, v135
  v_cvt_pk_bf16_f32 v162, v132, v133
  v_cvt_pk_bf16_f32 v163, v134, v135
  v_exp_f32 v136, v136
  v_exp_f32 v137, v137
  v_exp_f32 v138, v138
  v_exp_f32 v139, v139
  v_cvt_pk_bf16_f32 v164, v136, v137
  v_cvt_pk_bf16_f32 v165, v138, v139
  v_mfma_f32_32x32x16_bf16 v[64:79], v[176:179], v[160:163], 0
  s_mul_i32 s52, s52, 12288
  s_add_u32 s52, s52, 114688
  v_exp_f32 v140, v140
  v_exp_f32 v141, v141
  v_exp_f32 v142, v142
  v_exp_f32 v143, v143
  v_cvt_pk_bf16_f32 v166, v140, v141
  v_cvt_pk_bf16_f32 v167, v142, v143
  v_mfma_f32_32x32x16_bf16 v[128:143], v[168:171], v[48:51], 0
  global_load_dwordx4 v[216:219], v2, s[36:37] offset:0 sc1
  v_exp_f32 v144, v144
  v_exp_f32 v145, v145
  v_exp_f32 v146, v146
  v_exp_f32 v147, v147
  v_cvt_pk_bf16_f32 v160, v144, v145
  v_cvt_pk_bf16_f32 v161, v146, v147
  v_mfma_f32_32x32x16_bf16 v[128:143], v[172:175], v[52:55], v[128:143]
  global_load_dwordx4 v[220:223], v2, s[36:37] offset:1024 sc1
  v_exp_f32 v148, v148
  v_exp_f32 v149, v149
  v_exp_f32 v150, v150
  v_exp_f32 v151, v151
  v_cvt_pk_bf16_f32 v162, v148, v149
  v_cvt_pk_bf16_f32 v163, v150, v151
  v_mfma_f32_32x32x16_bf16 v[64:79], v[180:183], v[164:167], v[64:79]
  global_load_dwordx4 v[224:227], v2, s[36:37] offset:2048 sc1
  v_exp_f32 v152, v152
  v_exp_f32 v153, v153
  v_exp_f32 v154, v154
  v_exp_f32 v155, v155
  v_cvt_pk_bf16_f32 v164, v152, v153
  v_cvt_pk_bf16_f32 v165, v154, v155
  v_mfma_f32_32x32x16_bf16 v[80:95], v[176:179], v[160:163], 0
  global_load_dwordx4 v[228:231], v2, s[36:37] offset:3072 sc1
  v_exp_f32 v156, v156
  v_exp_f32 v157, v157
  v_exp_f32 v158, v158
  v_exp_f32 v159, v159
  v_cvt_pk_bf16_f32 v166, v156, v157
  v_cvt_pk_bf16_f32 v167, v158, v159
  v_mfma_f32_32x32x16_bf16 v[144:159], v[168:171], v[56:59], 0
  buffer_store_dwordx4 v[12:15], v2, s[20:23], s48 offen offset:3072 sc1
  v_exp_f32 v128, v128
  v_exp_f32 v129, v129
  v_exp_f32 v130, v130
  v_exp_f32 v131, v131
  v_cvt_pk_bf16_f32 v160, v128, v129
  v_cvt_pk_bf16_f32 v161, v130, v131
  v_mfma_f32_32x32x16_bf16 v[144:159], v[172:175], v[60:63], v[144:159]
  v_add_u32 v253, s52, v2
  s_add_u32 s52, s46, 2
  v_exp_f32 v132, v132
  v_exp_f32 v133, v133
  v_exp_f32 v134, v134
  v_exp_f32 v135, v135
  v_cvt_pk_bf16_f32 v162, v132, v133
  v_cvt_pk_bf16_f32 v163, v134, v135
  v_mfma_f32_32x32x16_bf16 v[80:95], v[180:183], v[164:167], v[80:95]
  s_and_b32 s52, s52, 3
  s_mul_i32 s52, s52, 12288
  v_exp_f32 v136, v136
  v_exp_f32 v137, v137
  v_exp_f32 v138, v138
  v_exp_f32 v139, v139
  v_cvt_pk_bf16_f32 v164, v136, v137
  v_cvt_pk_bf16_f32 v165, v138, v139
  v_mfma_f32_32x32x16_bf16 v[96:111], v[176:179], v[160:163], 0
  s_waitcnt vmcnt(12)
  v_exp_f32 v140, v140
  v_exp_f32 v141, v141
  v_exp_f32 v142, v142
  v_exp_f32 v143, v143
  v_cvt_pk_bf16_f32 v166, v140, v141
  v_cvt_pk_bf16_f32 v167, v142, v143
  v_mfma_f32_32x32x16_bf16 v[128:143], v[184:187], v[32:35], 0
  buffer_store_dwordx4 v[16:19], v2, s[20:23], s51 offen offset:0 sc1
  v_exp_f32 v144, v144
  v_exp_f32 v145, v145
  v_exp_f32 v146, v146
  v_exp_f32 v147, v147
  v_cvt_pk_bf16_f32 v160, v144, v145
  v_cvt_pk_bf16_f32 v161, v146, v147
  v_mfma_f32_32x32x16_bf16 v[128:143], v[188:191], v[36:39], v[128:143]
  s_add_u32 s52, s52, 118784
  v_add_u32 v254, s52, v2
  v_exp_f32 v148, v148
  v_exp_f32 v149, v149
  v_exp_f32 v150, v150
  v_exp_f32 v151, v151
  v_cvt_pk_bf16_f32 v162, v148, v149
  v_cvt_pk_bf16_f32 v163, v150, v151
  v_mfma_f32_32x32x16_bf16 v[96:111], v[180:183], v[164:167], v[96:111]
  s_add_u32 s52, s46, 3
  s_and_b32 s52, s52, 3
  v_exp_f32 v152, v152
  v_exp_f32 v153, v153
  v_exp_f32 v154, v154
  v_exp_f32 v155, v155
  v_cvt_pk_bf16_f32 v164, v152, v153
  v_cvt_pk_bf16_f32 v165, v154, v155
  v_mfma_f32_32x32x16_bf16 v[112:127], v[176:179], v[160:163], 0
  v_exp_f32 v156, v156
  v_exp_f32 v157, v157
  v_exp_f32 v158, v158
  v_exp_f32 v159, v159
  v_cvt_pk_bf16_f32 v166, v156, v157
  v_cvt_pk_bf16_f32 v167, v158, v159
  v_mfma_f32_32x32x16_bf16 v[144:159], v[184:187], v[40:43], 0
  buffer_store_dwordx4 v[20:23], v2, s[20:23], s51 offen offset:1024 sc1
  v_exp_f32 v128, v128
  v_exp_f32 v129, v129
  v_exp_f32 v130, v130
  v_exp_f32 v131, v131
  v_cvt_pk_bf16_f32 v160, v128, v129
  v_cvt_pk_bf16_f32 v161, v130, v131
  v_mfma_f32_32x32x16_bf16 v[144:159], v[188:191], v[44:47], v[144:159]
  s_add_u32 s36, s36, 8192
  s_addc_u32 s37, s37, 0
  v_exp_f32 v132, v132
  v_exp_f32 v133, v133
  v_exp_f32 v134, v134
  v_exp_f32 v135, v135
  v_cvt_pk_bf16_f32 v162, v132, v133
  v_cvt_pk_bf16_f32 v163, v134, v135
  v_mfma_f32_32x32x16_bf16 v[112:127], v[180:183], v[164:167], v[112:127]
  s_mul_i32 s52, s52, 12288
  s_add_u32 s52, s52, 122880
  v_exp_f32 v136, v136
  v_exp_f32 v137, v137
  v_exp_f32 v138, v138
  v_exp_f32 v139, v139
  v_cvt_pk_bf16_f32 v164, v136, v137
  v_cvt_pk_bf16_f32 v165, v138, v139
  v_mfma_f32_32x32x16_bf16 v[64:79], v[192:195], v[160:163], v[64:79]
  v_add_u32 v255, s52, v2
  s_mul_i32 s52, s46, 12288
  v_exp_f32 v140, v140
  v_exp_f32 v141, v141
  v_exp_f32 v142, v142
  v_exp_f32 v143, v143
  v_cvt_pk_bf16_f32 v166, v140, v141
  v_cvt_pk_bf16_f32 v167, v142, v143
  v_mfma_f32_32x32x16_bf16 v[128:143], v[184:187], v[48:51], 0
  global_load_dwordx4 v[168:171], v2, s[36:37] offset:-4096 sc1
  v_exp_f32 v144, v144
  v_exp_f32 v145, v145
  v_exp_f32 v146, v146
  v_exp_f32 v147, v147
  v_cvt_pk_bf16_f32 v160, v144, v145
  v_cvt_pk_bf16_f32 v161, v146, v147
  v_mfma_f32_32x32x16_bf16 v[128:143], v[188:191], v[52:55], v[128:143]
  global_load_dwordx4 v[172:175], v2, s[36:37] offset:-3072 sc1
  v_exp_f32 v148, v148
  v_exp_f32 v149, v149
  v_exp_f32 v150, v150
  v_exp_f32 v151, v151
  v_cvt_pk_bf16_f32 v162, v148, v149
  v_cvt_pk_bf16_f32 v163, v150, v151
  v_mfma_f32_32x32x16_bf16 v[64:79], v[196:199], v[164:167], v[64:79]
  global_load_dwordx4 v[176:179], v2, s[36:37] offset:-2048 sc1
  v_exp_f32 v152, v152
  v_exp_f32 v153, v153
  v_exp_f32 v154, v154
  v_exp_f32 v155, v155
  v_cvt_pk_bf16_f32 v164, v152, v153
  v_cvt_pk_bf16_f32 v165, v154, v155
  v_mfma_f32_32x32x16_bf16 v[80:95], v[192:195], v[160:163], v[80:95]
  global_load_dwordx4 v[180:183], v2, s[36:37] offset:-1024 sc1
  v_exp_f32 v156, v156
  v_exp_f32 v157, v157
  v_exp_f32 v158, v158
  v_exp_f32 v159, v159
  v_cvt_pk_bf16_f32 v166, v156, v157
  v_cvt_pk_bf16_f32 v167, v158, v159
  v_mfma_f32_32x32x16_bf16 v[144:159], v[184:187], v[56:59], 0
  buffer_store_dwordx4 v[232:235], v2, s[20:23], s51 offen offset:2048 sc1
  v_exp_f32 v128, v128
  v_exp_f32 v129, v129
  v_exp_f32 v130, v130
  v_exp_f32 v131, v131
  v_cvt_pk_bf16_f32 v160, v128, v129
  v_cvt_pk_bf16_f32 v161, v130, v131
  v_mfma_f32_32x32x16_bf16 v[144:159], v[188:191], v[60:63], v[144:159]
  s_add_u32 s52, s52, 114688
  v_add_u32 v252, s52, v2
  v_exp_f32 v132, v132
  v_exp_f32 v133, v133
  v_exp_f32 v134, v134
  v_exp_f32 v135, v135
  v_cvt_pk_bf16_f32 v162, v132, v133
  v_cvt_pk_bf16_f32 v163, v134, v135
  v_mfma_f32_32x32x16_bf16 v[80:95], v[196:199], v[164:167], v[80:95]
  buffer_store_dwordx4 v[236:239], v2, s[20:23], s51 offen offset:3072 sc1
  v_exp_f32 v136, v136
  v_exp_f32 v137, v137
  v_exp_f32 v138, v138
  v_exp_f32 v139, v139
  v_cvt_pk_bf16_f32 v164, v136, v137
  v_cvt_pk_bf16_f32 v165, v138, v139
  v_mfma_f32_32x32x16_bf16 v[96:111], v[192:195], v[160:163], v[96:111]
  s_waitcnt vmcnt(16)
  v_exp_f32 v140, v140
  v_exp_f32 v141, v141
  v_exp_f32 v142, v142
  v_exp_f32 v143, v143
  v_cvt_pk_bf16_f32 v166, v140, v141
  v_cvt_pk_bf16_f32 v167, v142, v143
  v_mfma_f32_32x32x16_bf16 v[128:143], v[200:203], v[32:35], 0
  v_exp_f32 v144, v144
  v_exp_f32 v145, v145
  v_exp_f32 v146, v146
  v_exp_f32 v147, v147
  v_cvt_pk_bf16_f32 v160, v144, v145
  v_cvt_pk_bf16_f32 v161, v146, v147
  v_mfma_f32_32x32x16_bf16 v[128:143], v[204:207], v[36:39], v[128:143]
  v_exp_f32 v148, v148
  v_exp_f32 v149, v149
  v_exp_f32 v150, v150
  v_exp_f32 v151, v151
  v_cvt_pk_bf16_f32 v162, v148, v149
  v_cvt_pk_bf16_f32 v163, v150, v151
  v_mfma_f32_32x32x16_bf16 v[96:111], v[196:199], v[164:167], v[96:111]
  v_exp_f32 v152, v152
  v_exp_f32 v153, v153
  v_exp_f32 v154, v154
  v_exp_f32 v155, v155
  v_cvt_pk_bf16_f32 v164, v152, v153
  v_cvt_pk_bf16_f32 v165, v154, v155
  v_mfma_f32_32x32x16_bf16 v[112:127], v[192:195], v[160:163], v[112:127]
  v_exp_f32 v156, v156
  v_exp_f32 v157, v157
  v_exp_f32 v158, v158
  v_exp_f32 v159, v159
  v_cvt_pk_bf16_f32 v166, v156, v157
  v_cvt_pk_bf16_f32 v167, v158, v159
  v_mfma_f32_32x32x16_bf16 v[144:159], v[200:203], v[40:43], 0
  v_exp_f32 v128, v128
  v_exp_f32 v129, v129
  v_exp_f32 v130, v130
  v_exp_f32 v131, v131
  v_cvt_pk_bf16_f32 v160, v128, v129
  v_cvt_pk_bf16_f32 v161, v130, v131
  v_mfma_f32_32x32x16_bf16 v[144:159], v[204:207], v[44:47], v[144:159]
  v_exp_f32 v132, v132
  v_exp_f32 v133, v133
  v_exp_f32 v134, v134
  v_exp_f32 v135, v135
  v_cvt_pk_bf16_f32 v162, v132, v133
  v_cvt_pk_bf16_f32 v163, v134, v135
  v_mfma_f32_32x32x16_bf16 v[112:127], v[196:199], v[164:167], v[112:127]
  v_exp_f32 v136, v136
  v_exp_f32 v137, v137
  v_exp_f32 v138, v138
  v_exp_f32 v139, v139
  v_cvt_pk_bf16_f32 v164, v136, v137
  v_cvt_pk_bf16_f32 v165, v138, v139
  v_mfma_f32_32x32x16_bf16 v[64:79], v[208:211], v[160:163], v[64:79]
  v_exp_f32 v140, v140
  v_exp_f32 v141, v141
  v_exp_f32 v142, v142
  v_exp_f32 v143, v143
  v_cvt_pk_bf16_f32 v166, v140, v141
  v_cvt_pk_bf16_f32 v167, v142, v143
  v_mfma_f32_32x32x16_bf16 v[128:143], v[200:203], v[48:51], 0
  global_load_dwordx4 v[184:187], v2, s[36:37] offset:0 sc1
  v_exp_f32 v144, v144
  v_exp_f32 v145, v145
  v_exp_f32 v146, v146
  v_exp_f32 v147, v147
  v_cvt_pk_bf16_f32 v160, v144, v145
  v_cvt_pk_bf16_f32 v161, v146, v147
  v_mfma_f32_32x32x16_bf16 v[128:143], v[204:207], v[52:55], v[128:143]
  global_load_dwordx4 v[188:191], v2, s[36:37] offset:1024 sc1
  v_exp_f32 v148, v148
  v_exp_f32 v149, v149
  v_exp_f32 v150, v150
  v_exp_f32 v151, v151
  v_cvt_pk_bf16_f32 v162, v148, v149
  v_cvt_pk_bf16_f32 v163, v150, v151
  v_mfma_f32_32x32x16_bf16 v[64:79], v[212:215], v[164:167], v[64:79]
  global_load_dwordx4 v[192:195], v2, s[36:37] offset:2048 sc1
  v_exp_f32 v152, v152
  v_exp_f32 v153, v153
  v_exp_f32 v154, v154
  v_exp_f32 v155, v155
  v_cvt_pk_bf16_f32 v164, v152, v153
  v_cvt_pk_bf16_f32 v165, v154, v155
  v_mfma_f32_32x32x16_bf16 v[80:95], v[208:211], v[160:163], v[80:95]
  global_load_dwordx4 v[196:199], v2, s[36:37] offset:3072 sc1
  v_exp_f32 v156, v156
  v_exp_f32 v157, v157
  v_exp_f32 v158, v158
  v_exp_f32 v159, v159
  v_cvt_pk_bf16_f32 v166, v156, v157
  v_cvt_pk_bf16_f32 v167, v158, v159
  v_mfma_f32_32x32x16_bf16 v[144:159], v[200:203], v[56:59], 0
  s_add_u32 m0, s47, 0
  s_mov_b32 s8, s49
  v_exp_f32 v128, v128
  v_exp_f32 v129, v129
  v_exp_f32 v130, v130
  v_exp_f32 v131, v131
  v_cvt_pk_bf16_f32 v160, v128, v129
  v_cvt_pk_bf16_f32 v161, v130, v131
  v_mfma_f32_32x32x16_bf16 v[144:159], v[204:207], v[60:63], v[144:159]
  s_mul_i32 s9, s8, 57344
  s_add_u32 s40, s6, s9
  s_addc_u32 s41, s7, 0
  v_exp_f32 v132, v132
  v_exp_f32 v133, v133
  v_exp_f32 v134, v134
  v_exp_f32 v135, v135
  v_cvt_pk_bf16_f32 v162, v132, v133
  v_cvt_pk_bf16_f32 v163, v134, v135
  v_mfma_f32_32x32x16_bf16 v[80:95], v[212:215], v[164:167], v[80:95]
  global_load_lds_dwordx4 v240, s[40:41] offset:0
  v_exp_f32 v136, v136
  v_exp_f32 v137, v137
  v_exp_f32 v138, v138
  v_exp_f32 v139, v139
  v_cvt_pk_bf16_f32 v164, v136, v137
  v_cvt_pk_bf16_f32 v165, v138, v139
  v_mfma_f32_32x32x16_bf16 v[96:111], v[208:211], v[160:163], v[96:111]
  s_waitcnt vmcnt(14)
  v_exp_f32 v140, v140
  v_exp_f32 v141, v141
  v_exp_f32 v142, v142
  v_exp_f32 v143, v143
  v_cvt_pk_bf16_f32 v166, v140, v141
  v_cvt_pk_bf16_f32 v167, v142, v143
  v_mfma_f32_32x32x16_bf16 v[128:143], v[216:219], v[32:35], 0
  global_load_lds_dwordx4 v241, s[40:41] offset:1024
  v_exp_f32 v144, v144
  v_exp_f32 v145, v145
  v_exp_f32 v146, v146
  v_exp_f32 v147, v147
  v_cvt_pk_bf16_f32 v160, v144, v145
  v_cvt_pk_bf16_f32 v161, v146, v147
  v_mfma_f32_32x32x16_bf16 v[128:143], v[220:223], v[36:39], v[128:143]
  global_load_lds_dwordx4 v242, s[40:41] offset:2048
  v_exp_f32 v148, v148
  v_exp_f32 v149, v149
  v_exp_f32 v150, v150
  v_exp_f32 v151, v151
  v_cvt_pk_bf16_f32 v162, v148, v149
  v_cvt_pk_bf16_f32 v163, v150, v151
  v_mfma_f32_32x32x16_bf16 v[96:111], v[212:215], v[164:167], v[96:111]
  global_load_lds_dwordx4 v243, s[40:41] offset:3072
  v_exp_f32 v152, v152
  v_exp_f32 v153, v153
  v_exp_f32 v154, v154
  v_exp_f32 v155, v155
  v_cvt_pk_bf16_f32 v164, v152, v153
  v_cvt_pk_bf16_f32 v165, v154, v155
  v_mfma_f32_32x32x16_bf16 v[112:127], v[208:211], v[160:163], v[112:127]
  s_add_u32 m0, s47, 4096
  s_add_u32 s40, s40, 28672
  s_addc_u32 s41, s41, 0
  v_exp_f32 v156, v156
  v_exp_f32 v157, v157
  v_exp_f32 v158, v158
  v_exp_f32 v159, v159
  v_cvt_pk_bf16_f32 v166, v156, v157
  v_cvt_pk_bf16_f32 v167, v158, v159
  v_mfma_f32_32x32x16_bf16 v[144:159], v[216:219], v[40:43], 0
  global_load_lds_dwordx4 v240, s[40:41] offset:0
  v_exp_f32 v128, v128
  v_exp_f32 v129, v129
  v_exp_f32 v130, v130
  v_exp_f32 v131, v131
  v_cvt_pk_bf16_f32 v160, v128, v129
  v_cvt_pk_bf16_f32 v161, v130, v131
  v_mfma_f32_32x32x16_bf16 v[144:159], v[220:223], v[44:47], v[144:159]
  s_add_u32 s36, s36, 8192
  s_addc_u32 s37, s37, 0
  v_exp_f32 v132, v132
  v_exp_f32 v133, v133
  v_exp_f32 v134, v134
  v_exp_f32 v135, v135
  v_cvt_pk_bf16_f32 v162, v132, v133
  v_cvt_pk_bf16_f32 v163, v134, v135
  v_mfma_f32_32x32x16_bf16 v[112:127], v[212:215], v[164:167], v[112:127]
  global_load_lds_dwordx4 v241, s[40:41] offset:1024
  v_exp_f32 v136, v136
  v_exp_f32 v137, v137
  v_exp_f32 v138, v138
  v_exp_f32 v139, v139
  v_cvt_pk_bf16_f32 v164, v136, v137
  v_cvt_pk_bf16_f32 v165, v138, v139
  v_mfma_f32_32x32x16_bf16 v[64:79], v[224:227], v[160:163], v[64:79]
  global_load_lds_dwordx4 v242, s[40:41] offset:2048
  v_exp_f32 v140, v140
  v_exp_f32 v141, v141
  v_exp_f32 v142, v142
  v_exp_f32 v143, v143
  v_cvt_pk_bf16_f32 v166, v140, v141
  v_cvt_pk_bf16_f32 v167, v142, v143
  v_mfma_f32_32x32x16_bf16 v[128:143], v[216:219], v[48:51], 0
  global_load_dwordx4 v[200:203], v2, s[36:37] offset:-4096 sc1
  v_exp_f32 v144, v144
  v_exp_f32 v145, v145
  v_exp_f32 v146, v146
  v_exp_f32 v147, v147
  v_cvt_pk_bf16_f32 v160, v144, v145
  v_cvt_pk_bf16_f32 v161, v146, v147
  v_mfma_f32_32x32x16_bf16 v[128:143], v[220:223], v[52:55], v[128:143]
  global_load_dwordx4 v[204:207], v2, s[36:37] offset:-3072 sc1
  v_exp_f32 v148, v148
  v_exp_f32 v149, v149
  v_exp_f32 v150, v150
  v_exp_f32 v151, v151
  v_cvt_pk_bf16_f32 v162, v148, v149
  v_cvt_pk_bf16_f32 v163, v150, v151
  v_mfma_f32_32x32x16_bf16 v[64:79], v[228:231], v[164:167], v[64:79]
  global_load_dwordx4 v[208:211], v2, s[36:37] offset:-2048 sc1
  v_exp_f32 v152, v152
  v_exp_f32 v153, v153
  v_exp_f32 v154, v154
  v_exp_f32 v155, v155
  v_cvt_pk_bf16_f32 v164, v152, v153
  v_cvt_pk_bf16_f32 v165, v154, v155
  v_mfma_f32_32x32x16_bf16 v[80:95], v[224:227], v[160:163], v[80:95]
  global_load_dwordx4 v[212:215], v2, s[36:37] offset:-1024 sc1
  v_exp_f32 v156, v156
  v_exp_f32 v157, v157
  v_exp_f32 v158, v158
  v_exp_f32 v159, v159
  v_cvt_pk_bf16_f32 v166, v156, v157
  v_cvt_pk_bf16_f32 v167, v158, v159
  v_mfma_f32_32x32x16_bf16 v[144:159], v[216:219], v[56:59], 0
  s_waitcnt vmcnt(15)
  v_exp_f32 v128, v128
  v_exp_f32 v129, v129
  v_exp_f32 v130, v130
  v_exp_f32 v131, v131
  v_cvt_pk_bf16_f32 v160, v128, v129
  v_cvt_pk_bf16_f32 v161, v130, v131
  v_mfma_f32_32x32x16_bf16 v[144:159], v[220:223], v[60:63], v[144:159]
  buffer_atomic_add v248, v249, s[20:23], s58 offen sc1
  v_exp_f32 v132, v132
  v_exp_f32 v133, v133
  v_exp_f32 v134, v134
  v_exp_f32 v135, v135
  v_cvt_pk_bf16_f32 v162, v132, v133
  v_cvt_pk_bf16_f32 v163, v134, v135
  v_mfma_f32_32x32x16_bf16 v[80:95], v[228:231], v[164:167], v[80:95]
  global_load_lds_dwordx4 v243, s[40:41] offset:3072
  v_exp_f32 v136, v136
  v_exp_f32 v137, v137
  v_exp_f32 v138, v138
  v_exp_f32 v139, v139
  v_cvt_pk_bf16_f32 v164, v136, v137
  v_cvt_pk_bf16_f32 v165, v138, v139
  v_mfma_f32_32x32x16_bf16 v[96:111], v[224:227], v[160:163], v[96:111]
  v_exp_f32 v140, v140
  v_exp_f32 v141, v141
  v_exp_f32 v142, v142
  v_exp_f32 v143, v143
  v_cvt_pk_bf16_f32 v166, v140, v141
  v_cvt_pk_bf16_f32 v167, v142, v143
  v_mfma_f32_32x32x16_bf16 v[128:143], v[168:171], v[32:35], 0
  s_add_u32 m0, s47, 8192
  s_add_u32 s8, s8, 1
  v_exp_f32 v144, v144
  v_exp_f32 v145, v145
  v_exp_f32 v146, v146
  v_exp_f32 v147, v147
  v_cvt_pk_bf16_f32 v160, v144, v145
  v_cvt_pk_bf16_f32 v161, v146, v147
  v_mfma_f32_32x32x16_bf16 v[128:143], v[172:175], v[36:39], v[128:143]
  s_cmp_eq_u32 s8, 7
  s_cselect_b32 s8, 0, s8
  s_mul_i32 s9, s8, 57344
  v_exp_f32 v148, v148
  v_exp_f32 v149, v149
  v_exp_f32 v150, v150
  v_exp_f32 v151, v151
  v_cvt_pk_bf16_f32 v162, v148, v149
  v_cvt_pk_bf16_f32 v163, v150, v151
  v_mfma_f32_32x32x16_bf16 v[96:111], v[228:231], v[164:167], v[96:111]
  s_add_u32 s40, s6, s9
  s_addc_u32 s41, s7, 0
  v_exp_f32 v152, v152
  v_exp_f32 v153, v153
  v_exp_f32 v154, v154
  v_exp_f32 v155, v155
  v_cvt_pk_bf16_f32 v164, v152, v153
  v_cvt_pk_bf16_f32 v165, v154, v155
  v_mfma_f32_32x32x16_bf16 v[112:127], v[224:227], v[160:163], v[112:127]
  global_load_lds_dwordx4 v240, s[40:41] offset:0
  v_exp_f32 v156, v156
  v_exp_f32 v157, v157
  v_exp_f32 v158, v158
  v_exp_f32 v159, v159
  v_cvt_pk_bf16_f32 v166, v156, v157
  v_cvt_pk_bf16_f32 v167, v158, v159
  v_mfma_f32_32x32x16_bf16 v[144:159], v[168:171], v[40:43], 0
  global_load_lds_dwordx4 v241, s[40:41] offset:1024
  v_exp_f32 v128, v128
  v_exp_f32 v129, v129
  v_exp_f32 v130, v130
  v_exp_f32 v131, v131
  v_cvt_pk_bf16_f32 v160, v128, v129
  v_cvt_pk_bf16_f32 v161, v130, v131
  v_mfma_f32_32x32x16_bf16 v[144:159], v[172:175], v[44:47], v[144:159]
  global_load_lds_dwordx4 v242, s[40:41] offset:2048
  v_exp_f32 v132, v132
  v_exp_f32 v133, v133
  v_exp_f32 v134, v134
  v_exp_f32 v135, v135
  v_cvt_pk_bf16_f32 v162, v132, v133
  v_cvt_pk_bf16_f32 v163, v134, v135
  v_mfma_f32_32x32x16_bf16 v[112:127], v[228:231], v[164:167], v[112:127]
  global_load_lds_dwordx4 v243, s[40:41] offset:3072
  v_exp_f32 v136, v136
  v_exp_f32 v137, v137
  v_exp_f32 v138, v138
  v_exp_f32 v139, v139
  v_cvt_pk_bf16_f32 v164, v136, v137
  v_cvt_pk_bf16_f32 v165, v138, v139
  v_mfma_f32_32x32x16_bf16 v[64:79], v[176:179], v[160:163], v[64:79]
  s_add_u32 m0, s47, 12288
  s_add_u32 s40, s40, 28672
  s_addc_u32 s41, s41, 0
  v_exp_f32 v140, v140
  v_exp_f32 v141, v141
  v_exp_f32 v142, v142
  v_exp_f32 v143, v143
  v_cvt_pk_bf16_f32 v166, v140, v141
  v_cvt_pk_bf16_f32 v167, v142, v143
  v_mfma_f32_32x32x16_bf16 v[128:143], v[168:171], v[48:51], 0
  global_load_dwordx4 v[216:219], v2, s[36:37] offset:0 sc1
  v_exp_f32 v144, v144
  v_exp_f32 v145, v145
  v_exp_f32 v146, v146
  v_exp_f32 v147, v147
  v_cvt_pk_bf16_f32 v160, v144, v145
  v_cvt_pk_bf16_f32 v161, v146, v147
  v_mfma_f32_32x32x16_bf16 v[128:143], v[172:175], v[52:55], v[128:143]
  global_load_dwordx4 v[220:223], v2, s[36:37] offset:1024 sc1
  v_exp_f32 v148, v148
  v_exp_f32 v149, v149
  v_exp_f32 v150, v150
  v_exp_f32 v151, v151
  v_cvt_pk_bf16_f32 v162, v148, v149
  v_cvt_pk_bf16_f32 v163, v150, v151
  v_mfma_f32_32x32x16_bf16 v[64:79], v[180:183], v[164:167], v[64:79]
  global_load_dwordx4 v[224:227], v2, s[36:37] offset:2048 sc1
  v_exp_f32 v152, v152
  v_exp_f32 v153, v153
  v_exp_f32 v154, v154
  v_exp_f32 v155, v155
  v_cvt_pk_bf16_f32 v164, v152, v153
  v_cvt_pk_bf16_f32 v165, v154, v155
  v_mfma_f32_32x32x16_bf16 v[80:95], v[176:179], v[160:163], v[80:95]
  global_load_dwordx4 v[228:231], v2, s[36:37] offset:3072 sc1
  v_exp_f32 v156, v156
  v_exp_f32 v157, v157
  v_exp_f32 v158, v158
  v_exp_f32 v159, v159
  v_cvt_pk_bf16_f32 v166, v156, v157
  v_cvt_pk_bf16_f32 v167, v158, v159
  v_mfma_f32_32x32x16_bf16 v[144:159], v[168:171], v[56:59], 0
  global_load_lds_dwordx4 v240, s[40:41] offset:0
  v_exp_f32 v128, v128
  v_exp_f32 v129, v129
  v_exp_f32 v130, v130
  v_exp_f32 v131, v131
  v_cvt_pk_bf16_f32 v160, v128, v129
  v_cvt_pk_bf16_f32 v161, v130, v131
  v_mfma_f32_32x32x16_bf16 v[144:159], v[172:175], v[60:63], v[144:159]
  global_load_lds_dwordx4 v241, s[40:41] offset:1024
  v_exp_f32 v132, v132
  v_exp_f32 v133, v133
  v_exp_f32 v134, v134
  v_exp_f32 v135, v135
  v_cvt_pk_bf16_f32 v162, v132, v133
  v_cvt_pk_bf16_f32 v163, v134, v135
  v_mfma_f32_32x32x16_bf16 v[80:95], v[180:183], v[164:167], v[80:95]
  global_load_lds_dwordx4 v242, s[40:41] offset:2048
  v_exp_f32 v136, v136
  v_exp_f32 v137, v137
  v_exp_f32 v138, v138
  v_exp_f32 v139, v139
  v_cvt_pk_bf16_f32 v164, v136, v137
  v_cvt_pk_bf16_f32 v165, v138, v139
  v_mfma_f32_32x32x16_bf16 v[96:111], v[176:179], v[160:163], v[96:111]
  s_waitcnt vmcnt(24)
  v_exp_f32 v140, v140
  v_exp_f32 v141, v141
  v_exp_f32 v142, v142
  v_exp_f32 v143, v143
  v_cvt_pk_bf16_f32 v166, v140, v141
  v_cvt_pk_bf16_f32 v167, v142, v143
  v_mfma_f32_32x32x16_bf16 v[128:143], v[184:187], v[32:35], 0
  global_load_lds_dwordx4 v243, s[40:41] offset:3072
  v_exp_f32 v144, v144
  v_exp_f32 v145, v145
  v_exp_f32 v146, v146
  v_exp_f32 v147, v147
  v_cvt_pk_bf16_f32 v160, v144, v145
  v_cvt_pk_bf16_f32 v161, v146, v147
  v_mfma_f32_32x32x16_bf16 v[128:143], v[188:191], v[36:39], v[128:143]
  s_add_u32 m0, s47, 16384
  s_add_u32 s8, s8, 1
  v_exp_f32 v148, v148
  v_exp_f32 v149, v149
  v_exp_f32 v150, v150
  v_exp_f32 v151, v151
  v_cvt_pk_bf16_f32 v162, v148, v149
  v_cvt_pk_bf16_f32 v163, v150, v151
  v_mfma_f32_32x32x16_bf16 v[96:111], v[180:183], v[164:167], v[96:111]
  s_cmp_eq_u32 s8, 7
  s_cselect_b32 s8, 0, s8
  s_mul_i32 s9, s8, 57344
  v_exp_f32 v152, v152
  v_exp_f32 v153, v153
  v_exp_f32 v154, v154
  v_exp_f32 v155, v155
  v_cvt_pk_bf16_f32 v164, v152, v153
  v_cvt_pk_bf16_f32 v165, v154, v155
  v_mfma_f32_32x32x16_bf16 v[112:127], v[176:179], v[160:163], v[112:127]
  s_add_u32 s40, s6, s9
  s_addc_u32 s41, s7, 0
  v_exp_f32 v156, v156
  v_exp_f32 v157, v157
  v_exp_f32 v158, v158
  v_exp_f32 v159, v159
  v_cvt_pk_bf16_f32 v166, v156, v157
  v_cvt_pk_bf16_f32 v167, v158, v159
  v_mfma_f32_32x32x16_bf16 v[144:159], v[184:187], v[40:43], 0
  global_load_lds_dwordx4 v240, s[40:41] offset:0
  v_exp_f32 v128, v128
  v_exp_f32 v129, v129
  v_exp_f32 v130, v130
  v_exp_f32 v131, v131
  v_cvt_pk_bf16_f32 v160, v128, v129
  v_cvt_pk_bf16_f32 v161, v130, v131
  v_mfma_f32_32x32x16_bf16 v[144:159], v[188:191], v[44:47], v[144:159]
  s_add_u32 s36, s36, 8192
  s_addc_u32 s37, s37, 0
  v_exp_f32 v132, v132
  v_exp_f32 v133, v133
  v_exp_f32 v134, v134
  v_exp_f32 v135, v135
  v_cvt_pk_bf16_f32 v162, v132, v133
  v_cvt_pk_bf16_f32 v163, v134, v135
  v_mfma_f32_32x32x16_bf16 v[112:127], v[180:183], v[164:167], v[112:127]
  global_load_lds_dwordx4 v241, s[40:41] offset:1024
  v_exp_f32 v136, v136
  v_exp_f32 v137, v137
  v_exp_f32 v138, v138
  v_exp_f32 v139, v139
  v_cvt_pk_bf16_f32 v164, v136, v137
  v_cvt_pk_bf16_f32 v165, v138, v139
  v_mfma_f32_32x32x16_bf16 v[64:79], v[192:195], v[160:163], v[64:79]
  global_load_lds_dwordx4 v242, s[40:41] offset:2048
  v_exp_f32 v140, v140
  v_exp_f32 v141, v141
  v_exp_f32 v142, v142
  v_exp_f32 v143, v143
  v_cvt_pk_bf16_f32 v166, v140, v141
  v_cvt_pk_bf16_f32 v167, v142, v143
  v_mfma_f32_32x32x16_bf16 v[128:143], v[184:187], v[48:51], 0
  global_load_dwordx4 v[168:171], v2, s[36:37] offset:-4096 sc1
  v_exp_f32 v144, v144
  v_exp_f32 v145, v145
  v_exp_f32 v146, v146
  v_exp_f32 v147, v147
  v_cvt_pk_bf16_f32 v160, v144, v145
  v_cvt_pk_bf16_f32 v161, v146, v147
  v_mfma_f32_32x32x16_bf16 v[128:143], v[188:191], v[52:55], v[128:143]
  global_load_dwordx4 v[172:175], v2, s[36:37] offset:-3072 sc1
  v_exp_f32 v148, v148
  v_exp_f32 v149, v149
  v_exp_f32 v150, v150
  v_exp_f32 v151, v151
  v_cvt_pk_bf16_f32 v162, v148, v149
  v_cvt_pk_bf16_f32 v163, v150, v151
  v_mfma_f32_32x32x16_bf16 v[64:79], v[196:199], v[164:167], v[64:79]
  global_load_dwordx4 v[176:179], v2, s[36:37] offset:-2048 sc1
  v_exp_f32 v152, v152
  v_exp_f32 v153, v153
  v_exp_f32 v154, v154
  v_exp_f32 v155, v155
  v_cvt_pk_bf16_f32 v164, v152, v153
  v_cvt_pk_bf16_f32 v165, v154, v155
  v_mfma_f32_32x32x16_bf16 v[80:95], v[192:195], v[160:163], v[80:95]
  global_load_dwordx4 v[180:183], v2, s[36:37] offset:-1024 sc1
  v_exp_f32 v156, v156
  v_exp_f32 v157, v157
  v_exp_f32 v158, v158
  v_exp_f32 v159, v159
  v_cvt_pk_bf16_f32 v166, v156, v157
  v_cvt_pk_bf16_f32 v167, v158, v159
  v_mfma_f32_32x32x16_bf16 v[144:159], v[184:187], v[56:59], 0
  global_load_lds_dwordx4 v243, s[40:41] offset:3072
  v_exp_f32 v128, v128
  v_exp_f32 v129, v129
  v_exp_f32 v130, v130
  v_exp_f32 v131, v131
  v_cvt_pk_bf16_f32 v160, v128, v129
  v_cvt_pk_bf16_f32 v161, v130, v131
  v_mfma_f32_32x32x16_bf16 v[144:159], v[188:191], v[60:63], v[144:159]
  s_add_u32 m0, s47, 20480
  s_add_u32 s40, s40, 28672
  s_addc_u32 s41, s41, 0
  v_exp_f32 v132, v132
  v_exp_f32 v133, v133
  v_exp_f32 v134, v134
  v_exp_f32 v135, v135
  v_cvt_pk_bf16_f32 v162, v132, v133
  v_cvt_pk_bf16_f32 v163, v134, v135
  v_mfma_f32_32x32x16_bf16 v[80:95], v[196:199], v[164:167], v[80:95]
  global_load_lds_dwordx4 v240, s[40:41] offset:0
  v_exp_f32 v136, v136
  v_exp_f32 v137, v137
  v_exp_f32 v138, v138
  v_exp_f32 v139, v139
  v_cvt_pk_bf16_f32 v164, v136, v137
  v_cvt_pk_bf16_f32 v165, v138, v139
  v_mfma_f32_32x32x16_bf16 v[96:111], v[192:195], v[160:163], v[96:111]
  s_waitcnt vmcnt(23)
  v_exp_f32 v140, v140
  v_exp_f32 v141, v141
  v_exp_f32 v142, v142
  v_exp_f32 v143, v143
  v_cvt_pk_bf16_f32 v166, v140, v141
  v_cvt_pk_bf16_f32 v167, v142, v143
  v_mfma_f32_32x32x16_bf16 v[128:143], v[200:203], v[32:35], 0
  global_load_lds_dwordx4 v241, s[40:41] offset:1024
  v_exp_f32 v144, v144
  v_exp_f32 v145, v145
  v_exp_f32 v146, v146
  v_exp_f32 v147, v147
  v_cvt_pk_bf16_f32 v160, v144, v145
  v_cvt_pk_bf16_f32 v161, v146, v147
  v_mfma_f32_32x32x16_bf16 v[128:143], v[204:207], v[36:39], v[128:143]
  global_load_lds_dwordx4 v242, s[40:41] offset:2048
  v_exp_f32 v148, v148
  v_exp_f32 v149, v149
  v_exp_f32 v150, v150
  v_exp_f32 v151, v151
  v_cvt_pk_bf16_f32 v162, v148, v149
  v_cvt_pk_bf16_f32 v163, v150, v151
  v_mfma_f32_32x32x16_bf16 v[96:111], v[196:199], v[164:167], v[96:111]
  global_load_lds_dwordx4 v243, s[40:41] offset:3072
  v_exp_f32 v152, v152
  v_exp_f32 v153, v153
  v_exp_f32 v154, v154
  v_exp_f32 v155, v155
  v_cvt_pk_bf16_f32 v164, v152, v153
  v_cvt_pk_bf16_f32 v165, v154, v155
  v_mfma_f32_32x32x16_bf16 v[112:127], v[192:195], v[160:163], v[112:127]
  s_add_u32 m0, s47, 24576
  s_add_u32 s8, s8, 1
  v_exp_f32 v156, v156
  v_exp_f32 v157, v157
  v_exp_f32 v158, v158
  v_exp_f32 v159, v159
  v_cvt_pk_bf16_f32 v166, v156, v157
  v_cvt_pk_bf16_f32 v167, v158, v159
  v_mfma_f32_32x32x16_bf16 v[144:159], v[200:203], v[40:43], 0
  s_cmp_eq_u32 s8, 7
  s_cselect_b32 s8, 0, s8
  s_mul_i32 s9, s8, 57344
  v_exp_f32 v128, v128
  v_exp_f32 v129, v129
  v_exp_f32 v130, v130
  v_exp_f32 v131, v131
  v_cvt_pk_bf16_f32 v160, v128, v129
  v_cvt_pk_bf16_f32 v161, v130, v131
  v_mfma_f32_32x32x16_bf16 v[144:159], v[204:207], v[44:47], v[144:159]
  s_add_u32 s40, s6, s9
  s_addc_u32 s41, s7, 0
  v_exp_f32 v132, v132
  v_exp_f32 v133, v133
  v_exp_f32 v134, v134
  v_exp_f32 v135, v135
  v_cvt_pk_bf16_f32 v162, v132, v133
  v_cvt_pk_bf16_f32 v163, v134, v135
  v_mfma_f32_32x32x16_bf16 v[112:127], v[196:199], v[164:167], v[112:127]
  global_load_lds_dwordx4 v240, s[40:41] offset:0
  v_exp_f32 v136, v136
  v_exp_f32 v137, v137
  v_exp_f32 v138, v138
  v_exp_f32 v139, v139
  v_cvt_pk_bf16_f32 v164, v136, v137
  v_cvt_pk_bf16_f32 v165, v138, v139
  v_mfma_f32_32x32x16_bf16 v[64:79], v[208:211], v[160:163], v[64:79]
  global_load_lds_dwordx4 v241, s[40:41] offset:1024
  v_exp_f32 v140, v140
  v_exp_f32 v141, v141
  v_exp_f32 v142, v142
  v_exp_f32 v143, v143
  v_cvt_pk_bf16_f32 v166, v140, v141
  v_cvt_pk_bf16_f32 v167, v142, v143
  v_mfma_f32_32x32x16_bf16 v[128:143], v[200:203], v[48:51], 0
  global_load_dwordx4 v[184:187], v2, s[36:37] offset:0 sc1
  v_exp_f32 v144, v144
  v_exp_f32 v145, v145
  v_exp_f32 v146, v146
  v_exp_f32 v147, v147
  v_cvt_pk_bf16_f32 v160, v144, v145
  v_cvt_pk_bf16_f32 v161, v146, v147
  v_mfma_f32_32x32x16_bf16 v[128:143], v[204:207], v[52:55], v[128:143]
  global_load_dwordx4 v[188:191], v2, s[36:37] offset:1024 sc1
  v_exp_f32 v148, v148
  v_exp_f32 v149, v149
  v_exp_f32 v150, v150
  v_exp_f32 v151, v151
  v_cvt_pk_bf16_f32 v162, v148, v149
  v_cvt_pk_bf16_f32 v163, v150, v151
  v_mfma_f32_32x32x16_bf16 v[64:79], v[212:215], v[164:167], v[64:79]
  global_load_dwordx4 v[192:195], v2, s[36:37] offset:2048 sc1
  v_exp_f32 v152, v152
  v_exp_f32 v153, v153
  v_exp_f32 v154, v154
  v_exp_f32 v155, v155
  v_cvt_pk_bf16_f32 v164, v152, v153
  v_cvt_pk_bf16_f32 v165, v154, v155
  v_mfma_f32_32x32x16_bf16 v[80:95], v[208:211], v[160:163], v[80:95]
  global_load_dwordx4 v[196:199], v2, s[36:37] offset:3072 sc1
  v_exp_f32 v156, v156
  v_exp_f32 v157, v157
  v_exp_f32 v158, v158
  v_exp_f32 v159, v159
  v_cvt_pk_bf16_f32 v166, v156, v157
  v_cvt_pk_bf16_f32 v167, v158, v159
  v_mfma_f32_32x32x16_bf16 v[144:159], v[200:203], v[56:59], 0
  buffer_load_dword v28, v250, s[20:23], s58 offen sc1
  v_exp_f32 v128, v128
  v_exp_f32 v129, v129
  v_exp_f32 v130, v130
  v_exp_f32 v131, v131
  v_cvt_pk_bf16_f32 v160, v128, v129
  v_cvt_pk_bf16_f32 v161, v130, v131
  v_mfma_f32_32x32x16_bf16 v[144:159], v[204:207], v[60:63], v[144:159]
  global_load_lds_dwordx4 v242, s[40:41] offset:2048
  v_exp_f32 v132, v132
  v_exp_f32 v133, v133
  v_exp_f32 v134, v134
  v_exp_f32 v135, v135
  v_cvt_pk_bf16_f32 v162, v132, v133
  v_cvt_pk_bf16_f32 v163, v134, v135
  v_mfma_f32_32x32x16_bf16 v[80:95], v[212:215], v[164:167], v[80:95]
  global_load_lds_dwordx4 v243, s[40:41] offset:3072
  v_exp_f32 v136, v136
  v_exp_f32 v137, v137
  v_exp_f32 v138, v138
  v_exp_f32 v139, v139
  v_cvt_pk_bf16_f32 v164, v136, v137
  v_cvt_pk_bf16_f32 v165, v138, v139
  v_mfma_f32_32x32x16_bf16 v[96:111], v[208:211], v[160:163], v[96:111]
  s_waitcnt vmcnt(25)
  v_exp_f32 v140, v140
  v_exp_f32 v141, v141
  v_exp_f32 v142, v142
  v_exp_f32 v143, v143
  v_cvt_pk_bf16_f32 v166, v140, v141
  v_cvt_pk_bf16_f32 v167, v142, v143
  v_mfma_f32_32x32x16_bf16 v[128:143], v[216:219], v[32:35], 0
  ds_read_b64_tr_b16 a[224:225], v26 offset:0
  ds_read_b64_tr_b16 a[226:227], v26 offset:1024
  v_exp_f32 v144, v144
  v_exp_f32 v145, v145
  v_exp_f32 v146, v146
  v_exp_f32 v147, v147
  v_cvt_pk_bf16_f32 v160, v144, v145
  v_cvt_pk_bf16_f32 v161, v146, v147
  v_mfma_f32_32x32x16_bf16 v[128:143], v[220:223], v[36:39], v[128:143]
  ds_read_b64_tr_b16 a[228:229], v27 offset:0
  ds_read_b64_tr_b16 a[230:231], v27 offset:1024
  v_exp_f32 v148, v148
  v_exp_f32 v149, v149
  v_exp_f32 v150, v150
  v_exp_f32 v151, v151
  v_cvt_pk_bf16_f32 v162, v148, v149
  v_cvt_pk_bf16_f32 v163, v150, v151
  v_mfma_f32_32x32x16_bf16 v[96:111], v[212:215], v[164:167], v[96:111]
  ds_read_b64_tr_b16 a[232:233], v26 offset:2048
  ds_read_b64_tr_b16 a[234:235], v26 offset:3072
  v_exp_f32 v152, v152
  v_exp_f32 v153, v153
  v_exp_f32 v154, v154
  v_exp_f32 v155, v155
  v_cvt_pk_bf16_f32 v164, v152, v153
  v_cvt_pk_bf16_f32 v165, v154, v155
  v_mfma_f32_32x32x16_bf16 v[112:127], v[208:211], v[160:163], v[112:127]
  ds_read_b64_tr_b16 a[236:237], v27 offset:2048
  ds_read_b64_tr_b16 a[238:239], v27 offset:3072
  v_exp_f32 v156, v156
  v_exp_f32 v157, v157
  v_exp_f32 v158, v158
  v_exp_f32 v159, v159
  v_cvt_pk_bf16_f32 v166, v156, v157
  v_cvt_pk_bf16_f32 v167, v158, v159
  v_mfma_f32_32x32x16_bf16 v[144:159], v[216:219], v[40:43], 0
  s_add_u32 m0, s47, 0
  s_add_u32 s40, s40, 28672
  s_addc_u32 s41, s41, 0
  v_exp_f32 v128, v128
  v_exp_f32 v129, v129
  v_exp_f32 v130, v130
  v_exp_f32 v131, v131
  v_cvt_pk_bf16_f32 v160, v128, v129
  v_cvt_pk_bf16_f32 v161, v130, v131
  v_mfma_f32_32x32x16_bf16 v[144:159], v[220:223], v[44:47], v[144:159]
  s_add_u32 s36, s36, 8192
  s_addc_u32 s37, s37, 0
  v_exp_f32 v132, v132
  v_exp_f32 v133, v133
  v_exp_f32 v134, v134
  v_exp_f32 v135, v135
  v_cvt_pk_bf16_f32 v162, v132, v133
  v_cvt_pk_bf16_f32 v163, v134, v135
  v_mfma_f32_32x32x16_bf16 v[112:127], v[212:215], v[164:167], v[112:127]
  s_waitcnt lgkmcnt(0)
  global_load_lds_dwordx4 v240, s[40:41] offset:0
  v_exp_f32 v136, v136
  v_exp_f32 v137, v137
  v_exp_f32 v138, v138
  v_exp_f32 v139, v139
  v_cvt_pk_bf16_f32 v164, v136, v137
  v_cvt_pk_bf16_f32 v165, v138, v139
  v_mfma_f32_32x32x16_bf16 v[64:79], v[224:227], v[160:163], v[64:79]
  global_load_lds_dwordx4 v241, s[40:41] offset:1024
  v_exp_f32 v140, v140
  v_exp_f32 v141, v141
  v_exp_f32 v142, v142
  v_exp_f32 v143, v143
  v_cvt_pk_bf16_f32 v166, v140, v141
  v_cvt_pk_bf16_f32 v167, v142, v143
  v_mfma_f32_32x32x16_bf16 v[128:143], v[216:219], v[48:51], 0
  global_load_dwordx4 v[200:203], v2, s[36:37] offset:-4096 sc1
  v_exp_f32 v144, v144
  v_exp_f32 v145, v145
  v_exp_f32 v146, v146
  v_exp_f32 v147, v147
  v_cvt_pk_bf16_f32 v160, v144, v145
  v_cvt_pk_bf16_f32 v161, v146, v147
  v_mfma_f32_32x32x16_bf16 v[128:143], v[220:223], v[52:55], v[128:143]
  global_load_dwordx4 v[204:207], v2, s[36:37] offset:-3072 sc1
  v_exp_f32 v148, v148
  v_exp_f32 v149, v149
  v_exp_f32 v150, v150
  v_exp_f32 v151, v151
  v_cvt_pk_bf16_f32 v162, v148, v149
  v_cvt_pk_bf16_f32 v163, v150, v151
  v_mfma_f32_32x32x16_bf16 v[64:79], v[228:231], v[164:167], v[64:79]
  global_load_dwordx4 v[208:211], v2, s[36:37] offset:-2048 sc1
  v_exp_f32 v152, v152
  v_exp_f32 v153, v153
  v_exp_f32 v154, v154
  v_exp_f32 v155, v155
  v_cvt_pk_bf16_f32 v164, v152, v153
  v_cvt_pk_bf16_f32 v165, v154, v155
  v_mfma_f32_32x32x16_bf16 v[80:95], v[224:227], v[160:163], v[80:95]
  global_load_dwordx4 v[212:215], v2, s[36:37] offset:-1024 sc1
  v_exp_f32 v156, v156
  v_exp_f32 v157, v157
  v_exp_f32 v158, v158
  v_exp_f32 v159, v159
  v_cvt_pk_bf16_f32 v166, v156, v157
  v_cvt_pk_bf16_f32 v167, v158, v159
  v_mfma_f32_32x32x16_bf16 v[144:159], v[216:219], v[56:59], 0
  global_load_lds_dwordx4 v242, s[40:41] offset:2048
  v_exp_f32 v128, v128
  v_exp_f32 v129, v129
  v_exp_f32 v130, v130
  v_exp_f32 v131, v131
  v_cvt_pk_bf16_f32 v160, v128, v129
  v_cvt_pk_bf16_f32 v161, v130, v131
  v_mfma_f32_32x32x16_bf16 v[144:159], v[220:223], v[60:63], v[144:159]
  global_load_lds_dwordx4 v243, s[40:41] offset:3072
  v_exp_f32 v132, v132
  v_exp_f32 v133, v133
  v_exp_f32 v134, v134
  v_exp_f32 v135, v135
  v_cvt_pk_bf16_f32 v162, v132, v133
  v_cvt_pk_bf16_f32 v163, v134, v135
  v_mfma_f32_32x32x16_bf16 v[80:95], v[228:231], v[164:167], v[80:95]
  ds_read_b64_tr_b16 a[240:241], v26 offset:4096
  ds_read_b64_tr_b16 a[242:243], v26 offset:5120
  v_exp_f32 v136, v136
  v_exp_f32 v137, v137
  v_exp_f32 v138, v138
  v_exp_f32 v139, v139
  v_cvt_pk_bf16_f32 v164, v136, v137
  v_cvt_pk_bf16_f32 v165, v138, v139
  v_mfma_f32_32x32x16_bf16 v[96:111], v[224:227], v[160:163], v[96:111]
  s_waitcnt vmcnt(22)
  v_exp_f32 v140, v140
  v_exp_f32 v141, v141
  v_exp_f32 v142, v142
  v_exp_f32 v143, v143
  v_cvt_pk_bf16_f32 v166, v140, v141
  v_cvt_pk_bf16_f32 v167, v142, v143
  v_mfma_f32_32x32x16_bf16 v[128:143], v[168:171], v[32:35], 0
  ds_read_b64_tr_b16 a[244:245], v27 offset:4096
  ds_read_b64_tr_b16 a[246:247], v27 offset:5120
  v_exp_f32 v144, v144
  v_exp_f32 v145, v145
  v_exp_f32 v146, v146
  v_exp_f32 v147, v147
  v_cvt_pk_bf16_f32 v160, v144, v145
  v_cvt_pk_bf16_f32 v161, v146, v147
  v_mfma_f32_32x32x16_bf16 v[128:143], v[172:175], v[36:39], v[128:143]
  ds_read_b64_tr_b16 a[248:249], v26 offset:6144
  ds_read_b64_tr_b16 a[250:251], v26 offset:7168
  v_exp_f32 v148, v148
  v_exp_f32 v149, v149
  v_exp_f32 v150, v150
  v_exp_f32 v151, v151
  v_cvt_pk_bf16_f32 v162, v148, v149
  v_cvt_pk_bf16_f32 v163, v150, v151
  v_mfma_f32_32x32x16_bf16 v[96:111], v[228:231], v[164:167], v[96:111]
  ds_read_b64_tr_b16 a[252:253], v27 offset:6144
  ds_read_b64_tr_b16 a[254:255], v27 offset:7168
  v_exp_f32 v152, v152
  v_exp_f32 v153, v153
  v_exp_f32 v154, v154
  v_exp_f32 v155, v155
  v_cvt_pk_bf16_f32 v164, v152, v153
  v_cvt_pk_bf16_f32 v165, v154, v155
  v_mfma_f32_32x32x16_bf16 v[112:127], v[224:227], v[160:163], v[112:127]
  s_add_u32 m0, s47, 4096
  s_add_u32 s8, s8, 1
  v_exp_f32 v156, v156
  v_exp_f32 v157, v157
  v_exp_f32 v158, v158
  v_exp_f32 v159, v159
  v_cvt_pk_bf16_f32 v166, v156, v157
  v_cvt_pk_bf16_f32 v167, v158, v159
  v_mfma_f32_32x32x16_bf16 v[144:159], v[168:171], v[40:43], 0
  s_cmp_eq_u32 s8, 7
  s_cselect_b32 s8, 0, s8
  s_mul_i32 s9, s8, 57344
  v_exp_f32 v128, v128
  v_exp_f32 v129, v129
  v_exp_f32 v130, v130
  v_exp_f32 v131, v131
  v_cvt_pk_bf16_f32 v160, v128, v129
  v_cvt_pk_bf16_f32 v161, v130, v131
  v_mfma_f32_32x32x16_bf16 v[144:159], v[172:175], v[44:47], v[144:159]
  s_add_u32 s40, s6, s9
  s_addc_u32 s41, s7, 0
  v_exp_f32 v132, v132
  v_exp_f32 v133, v133
  v_exp_f32 v134, v134
  v_exp_f32 v135, v135
  v_cvt_pk_bf16_f32 v162, v132, v133
  v_cvt_pk_bf16_f32 v163, v134, v135
  v_mfma_f32_32x32x16_bf16 v[112:127], v[228:231], v[164:167], v[112:127]
  s_waitcnt lgkmcnt(0)
  global_load_lds_dwordx4 v240, s[40:41] offset:0
  v_exp_f32 v136, v136
  v_exp_f32 v137, v137
  v_exp_f32 v138, v138
  v_exp_f32 v139, v139
  v_cvt_pk_bf16_f32 v164, v136, v137
  v_cvt_pk_bf16_f32 v165, v138, v139
  v_mfma_f32_32x32x16_bf16 v[64:79], v[176:179], v[160:163], v[64:79]
  global_load_lds_dwordx4 v241, s[40:41] offset:1024
  v_exp_f32 v140, v140
  v_exp_f32 v141, v141
  v_exp_f32 v142, v142
  v_exp_f32 v143, v143
  v_cvt_pk_bf16_f32 v166, v140, v141
  v_cvt_pk_bf16_f32 v167, v142, v143
  v_mfma_f32_32x32x16_bf16 v[128:143], v[168:171], v[48:51], 0
  global_load_dwordx4 v[216:219], v2, s[36:37] offset:0 sc1
  v_exp_f32 v144, v144
  v_exp_f32 v145, v145
  v_exp_f32 v146, v146
  v_exp_f32 v147, v147
  v_cvt_pk_bf16_f32 v160, v144, v145
  v_cvt_pk_bf16_f32 v161, v146, v147
  v_mfma_f32_32x32x16_bf16 v[128:143], v[172:175], v[52:55], v[128:143]
  global_load_dwordx4 v[220:223], v2, s[36:37] offset:1024 sc1
  v_exp_f32 v148, v148
  v_exp_f32 v149, v149
  v_exp_f32 v150, v150
  v_exp_f32 v151, v151
  v_cvt_pk_bf16_f32 v162, v148, v149
  v_cvt_pk_bf16_f32 v163, v150, v151
  v_mfma_f32_32x32x16_bf16 v[64:79], v[180:183], v[164:167], v[64:79]
  global_load_dwordx4 v[224:227], v2, s[36:37] offset:2048 sc1
  v_exp_f32 v152, v152
  v_exp_f32 v153, v153
  v_exp_f32 v154, v154
  v_exp_f32 v155, v155
  v_cvt_pk_bf16_f32 v164, v152, v153
  v_cvt_pk_bf16_f32 v165, v154, v155
  v_mfma_f32_32x32x16_bf16 v[80:95], v[176:179], v[160:163], v[80:95]
  global_load_dwordx4 v[228:231], v2, s[36:37] offset:3072 sc1
  v_exp_f32 v156, v156
  v_exp_f32 v157, v157
  v_exp_f32 v158, v158
  v_exp_f32 v159, v159
  v_cvt_pk_bf16_f32 v166, v156, v157
  v_cvt_pk_bf16_f32 v167, v158, v159
  v_mfma_f32_32x32x16_bf16 v[144:159], v[168:171], v[56:59], 0
  global_load_lds_dwordx4 v242, s[40:41] offset:2048
  v_exp_f32 v128, v128
  v_exp_f32 v129, v129
  v_exp_f32 v130, v130
  v_exp_f32 v131, v131
  v_cvt_pk_bf16_f32 v160, v128, v129
  v_cvt_pk_bf16_f32 v161, v130, v131
  v_mfma_f32_32x32x16_bf16 v[144:159], v[172:175], v[60:63], v[144:159]
  global_load_lds_dwordx4 v243, s[40:41] offset:3072
  v_exp_f32 v132, v132
  v_exp_f32 v133, v133
  v_exp_f32 v134, v134
  v_exp_f32 v135, v135
  v_cvt_pk_bf16_f32 v162, v132, v133
  v_cvt_pk_bf16_f32 v163, v134, v135
  v_mfma_f32_32x32x16_bf16 v[80:95], v[180:183], v[164:167], v[80:95]
  ds_read_b64_tr_b16 v[8:9], v26 offset:8192
  ds_read_b64_tr_b16 v[10:11], v26 offset:9216
  v_exp_f32 v136, v136
  v_exp_f32 v137, v137
  v_exp_f32 v138, v138
  v_exp_f32 v139, v139
  v_cvt_pk_bf16_f32 v164, v136, v137
  v_cvt_pk_bf16_f32 v165, v138, v139
  v_mfma_f32_32x32x16_bf16 v[96:111], v[176:179], v[160:163], v[96:111]
  s_waitcnt vmcnt(19)
  v_exp_f32 v140, v140
  v_exp_f32 v141, v141
  v_exp_f32 v142, v142
  v_exp_f32 v143, v143
  v_cvt_pk_bf16_f32 v166, v140, v141
  v_cvt_pk_bf16_f32 v167, v142, v143
  v_mfma_f32_32x32x16_bf16 v[128:143], v[184:187], v[32:35], 0
  ds_read_b64_tr_b16 v[12:13], v27 offset:8192
  ds_read_b64_tr_b16 v[14:15], v27 offset:9216
  v_exp_f32 v144, v144
  v_exp_f32 v145, v145
  v_exp_f32 v146, v146
  v_exp_f32 v147, v147
  v_cvt_pk_bf16_f32 v160, v144, v145
  v_cvt_pk_bf16_f32 v161, v146, v147
  v_mfma_f32_32x32x16_bf16 v[128:143], v[188:191], v[36:39], v[128:143]
  ds_read_b64_tr_b16 v[16:17], v26 offset:10240
  ds_read_b64_tr_b16 v[18:19], v26 offset:11264
  v_exp_f32 v148, v148
  v_exp_f32 v149, v149
  v_exp_f32 v150, v150
  v_exp_f32 v151, v151
  v_cvt_pk_bf16_f32 v162, v148, v149
  v_cvt_pk_bf16_f32 v163, v150, v151
  v_mfma_f32_32x32x16_bf16 v[96:111], v[180:183], v[164:167], v[96:111]
  ds_read_b64_tr_b16 v[20:21], v27 offset:10240
  ds_read_b64_tr_b16 v[22:23], v27 offset:11264
  v_exp_f32 v152, v152
  v_exp_f32 v153, v153
  v_exp_f32 v154, v154
  v_exp_f32 v155, v155
  v_cvt_pk_bf16_f32 v164, v152, v153
  v_cvt_pk_bf16_f32 v165, v154, v155
  v_mfma_f32_32x32x16_bf16 v[112:127], v[176:179], v[160:163], v[112:127]
  s_add_u32 m0, s47, 8192
  s_add_u32 s40, s40, 28672
  s_addc_u32 s41, s41, 0
  v_exp_f32 v156, v156
  v_exp_f32 v157, v157
  v_exp_f32 v158, v158
  v_exp_f32 v159, v159
  v_cvt_pk_bf16_f32 v166, v156, v157
  v_cvt_pk_bf16_f32 v167, v158, v159
  v_mfma_f32_32x32x16_bf16 v[144:159], v[184:187], v[40:43], 0
  s_waitcnt lgkmcnt(0)
  global_load_lds_dwordx4 v240, s[40:41] offset:0
  v_exp_f32 v128, v128
  v_exp_f32 v129, v129
  v_exp_f32 v130, v130
  v_exp_f32 v131, v131
  v_cvt_pk_bf16_f32 v160, v128, v129
  v_cvt_pk_bf16_f32 v161, v130, v131
  v_mfma_f32_32x32x16_bf16 v[144:159], v[188:191], v[44:47], v[144:159]
  s_add_u32 s36, s36, 8192
  s_addc_u32 s37, s37, 0
  v_exp_f32 v132, v132
  v_exp_f32 v133, v133
  v_exp_f32 v134, v134
  v_exp_f32 v135, v135
  v_cvt_pk_bf16_f32 v162, v132, v133
  v_cvt_pk_bf16_f32 v163, v134, v135
  v_mfma_f32_32x32x16_bf16 v[112:127], v[180:183], v[164:167], v[112:127]
  global_load_lds_dwordx4 v241, s[40:41] offset:1024
  v_exp_f32 v136, v136
  v_exp_f32 v137, v137
  v_exp_f32 v138, v138
  v_exp_f32 v139, v139
  v_cvt_pk_bf16_f32 v164, v136, v137
  v_cvt_pk_bf16_f32 v165, v138, v139
  v_mfma_f32_32x32x16_bf16 v[64:79], v[192:195], v[160:163], v[64:79]
  global_load_lds_dwordx4 v242, s[40:41] offset:2048
  v_exp_f32 v140, v140
  v_exp_f32 v141, v141
  v_exp_f32 v142, v142
  v_exp_f32 v143, v143
  v_cvt_pk_bf16_f32 v166, v140, v141
  v_cvt_pk_bf16_f32 v167, v142, v143
  v_mfma_f32_32x32x16_bf16 v[128:143], v[184:187], v[48:51], 0
  global_load_dwordx4 v[168:171], v2, s[36:37] offset:-4096 sc1
  v_exp_f32 v144, v144
  v_exp_f32 v145, v145
  v_exp_f32 v146, v146
  v_exp_f32 v147, v147
  v_cvt_pk_bf16_f32 v160, v144, v145
  v_cvt_pk_bf16_f32 v161, v146, v147
  v_mfma_f32_32x32x16_bf16 v[128:143], v[188:191], v[52:55], v[128:143]
  global_load_dwordx4 v[172:175], v2, s[36:37] offset:-3072 sc1
  v_exp_f32 v148, v148
  v_exp_f32 v149, v149
  v_exp_f32 v150, v150
  v_exp_f32 v151, v151
  v_cvt_pk_bf16_f32 v162, v148, v149
  v_cvt_pk_bf16_f32 v163, v150, v151
  v_mfma_f32_32x32x16_bf16 v[64:79], v[196:199], v[164:167], v[64:79]
  global_load_dwordx4 v[176:179], v2, s[36:37] offset:-2048 sc1
  v_exp_f32 v152, v152
  v_exp_f32 v153, v153
  v_exp_f32 v154, v154
  v_exp_f32 v155, v155
  v_cvt_pk_bf16_f32 v164, v152, v153
  v_cvt_pk_bf16_f32 v165, v154, v155
  v_mfma_f32_32x32x16_bf16 v[80:95], v[192:195], v[160:163], v[80:95]
  global_load_dwordx4 v[180:183], v2, s[36:37] offset:-1024 sc1
  v_exp_f32 v156, v156
  v_exp_f32 v157, v157
  v_exp_f32 v158, v158
  v_exp_f32 v159, v159
  v_cvt_pk_bf16_f32 v166, v156, v157
  v_cvt_pk_bf16_f32 v167, v158, v159
  v_mfma_f32_32x32x16_bf16 v[144:159], v[184:187], v[56:59], 0
  global_load_lds_dwordx4 v243, s[40:41] offset:3072
  v_exp_f32 v128, v128
  v_exp_f32 v129, v129
  v_exp_f32 v130, v130
  v_exp_f32 v131, v131
  v_cvt_pk_bf16_f32 v160, v128, v129
  v_cvt_pk_bf16_f32 v161, v130, v131
  v_mfma_f32_32x32x16_bf16 v[144:159], v[188:191], v[60:63], v[144:159]
  s_waitcnt vmcnt(26)
  v_readfirstlane_b32 s52, v28
  s_cmp_ge_u32 s52, 64
  s_cbranch_scc0 L_sp2
L_ok2:
  v_exp_f32 v132, v132
  v_exp_f32 v133, v133
  v_exp_f32 v134, v134
  v_exp_f32 v135, v135
  v_cvt_pk_bf16_f32 v162, v132, v133
  v_cvt_pk_bf16_f32 v163, v134, v135
  v_mfma_f32_32x32x16_bf16 v[80:95], v[196:199], v[164:167], v[80:95]
  s_add_u32 s54, s2, 589824
  s_lshl_b32 s52, s64, 8
  v_exp_f32 v136, v136
  v_exp_f32 v137, v137
  v_exp_f32 v138, v138
  v_exp_f32 v139, v139
  v_cvt_pk_bf16_f32 v164, v136, v137
  v_cvt_pk_bf16_f32 v165, v138, v139
  v_mfma_f32_32x32x16_bf16 v[96:111], v[192:195], v[160:163], v[96:111]
  s_waitcnt vmcnt(18)
  v_exp_f32 v140, v140
  v_exp_f32 v141, v141
  v_exp_f32 v142, v142
  v_exp_f32 v143, v143
  v_cvt_pk_bf16_f32 v166, v140, v141
  v_cvt_pk_bf16_f32 v167, v142, v143
  v_mfma_f32_32x32x16_bf16 v[128:143], v[200:203], v[32:35], 0
  s_add_u32 s52, s52, s54
  s_lshl_b32 s53, s46, 7
  v_exp_f32 v144, v144
  v_exp_f32 v145, v145
  v_exp_f32 v146, v146
  v_exp_f32 v147, v147
  v_cvt_pk_bf16_f32 v160, v144, v145
  v_cvt_pk_bf16_f32 v161, v146, v147
  v_mfma_f32_32x32x16_bf16 v[128:143], v[204:207], v[36:39], v[128:143]
  s_add_u32 s53, s53, s54
  v_exp_f32 v148, v148
  v_exp_f32 v149, v149
  v_exp_f32 v150, v150
  v_exp_f32 v151, v151
  v_cvt_pk_bf16_f32 v162, v148, v149
  v_cvt_pk_bf16_f32 v163, v150, v151
  v_mfma_f32_32x32x16_bf16 v[96:111], v[196:199], v[164:167], v[96:111]
  buffer_load_dword v29, v4, s[20:23], s53 offen sc1
  v_exp_f32 v152, v152
  v_exp_f32 v153, v153
  v_exp_f32 v154, v154
  v_exp_f32 v155, v155
  v_cvt_pk_bf16_f32 v164, v152, v153
  v_cvt_pk_bf16_f32 v165, v154, v155
  v_mfma_f32_32x32x16_bf16 v[112:127], v[192:195], v[160:163], v[112:127]
  buffer_load_dword v30, v3, s[20:23], s52 offen sc1
  v_exp_f32 v156, v156
  v_exp_f32 v157, v157
  v_exp_f32 v158, v158
  v_exp_f32 v159, v159
  v_cvt_pk_bf16_f32 v166, v156, v157
  v_cvt_pk_bf16_f32 v167, v158, v159
  v_mfma_f32_32x32x16_bf16 v[144:159], v[200:203], v[40:43], 0
  buffer_load_dword v31, v6, s[20:23], s52 offen sc1
  v_exp_f32 v128, v128
  v_exp_f32 v129, v129
  v_exp_f32 v130, v130
  v_exp_f32 v131, v131
  v_cvt_pk_bf16_f32 v160, v128, v129
  v_cvt_pk_bf16_f32 v161, v130, v131
  v_mfma_f32_32x32x16_bf16 v[144:159], v[204:207], v[44:47], v[144:159]
  s_mov_b32 s10, s49
  s_lshl_b32 s11, s10, 12
  v_exp_f32 v132, v132
  v_exp_f32 v133, v133
  v_exp_f32 v134, v134
  v_exp_f32 v135, v135
  v_cvt_pk_bf16_f32 v162, v132, v133
  v_cvt_pk_bf16_f32 v163, v134, v135
  v_mfma_f32_32x32x16_bf16 v[112:127], v[196:199], v[164:167], v[112:127]
  s_add_u32 s38, s4, s11
  s_addc_u32 s39, s5, 0
  v_exp_f32 v136, v136
  v_exp_f32 v137, v137
  v_exp_f32 v138, v138
  v_exp_f32 v139, v139
  v_cvt_pk_bf16_f32 v164, v136, v137
  v_cvt_pk_bf16_f32 v165, v138, v139
  v_mfma_f32_32x32x16_bf16 v[64:79], v[208:211], v[160:163], v[64:79]
  global_load_dwordx4 a[0:3], v244, s[38:39] offset:0 sc1
  v_exp_f32 v140, v140
  v_exp_f32 v141, v141
  v_exp_f32 v142, v142
  v_exp_f32 v143, v143
  v_cvt_pk_bf16_f32 v166, v140, v141
  v_cvt_pk_bf16_f32 v167, v142, v143
  v_mfma_f32_32x32x16_bf16 v[128:143], v[200:203], v[48:51], 0
  global_load_dwordx4 v[184:187], v2, s[36:37] offset:0 sc1
  v_exp_f32 v144, v144
  v_exp_f32 v145, v145
  v_exp_f32 v146, v146
  v_exp_f32 v147, v147
  v_cvt_pk_bf16_f32 v160, v144, v145
  v_cvt_pk_bf16_f32 v161, v146, v147
  v_mfma_f32_32x32x16_bf16 v[128:143], v[204:207], v[52:55], v[128:143]
  global_load_dwordx4 v[188:191], v2, s[36:37] offset:1024 sc1
  v_exp_f32 v148, v148
  v_exp_f32 v149, v149
  v_exp_f32 v150, v150
  v_exp_f32 v151, v151
  v_cvt_pk_bf16_f32 v162, v148, v149
  v_cvt_pk_bf16_f32 v163, v150, v151
  v_mfma_f32_32x32x16_bf16 v[64:79], v[212:215], v[164:167], v[64:79]
  global_load_dwordx4 v[192:195], v2, s[36:37] offset:2048 sc1
  v_exp_f32 v152, v152
  v_exp_f32 v153, v153
  v_exp_f32 v154, v154
  v_exp_f32 v155, v155
  v_cvt_pk_bf16_f32 v164, v152, v153
  v_cvt_pk_bf16_f32 v165, v154, v155
  v_mfma_f32_32x32x16_bf16 v[80:95], v[208:211], v[160:163], v[80:95]
  global_load_dwordx4 v[196:199], v2, s[36:37] offset:3072 sc1
  v_exp_f32 v156, v156
  v_exp_f32 v157, v157
  v_exp_f32 v158, v158
  v_exp_f32 v159, v159
  v_cvt_pk_bf16_f32 v166, v156, v157
  v_cvt_pk_bf16_f32 v167, v158, v159
  v_mfma_f32_32x32x16_bf16 v[144:159], v[200:203], v[56:59], 0
  global_load_dwordx4 a[4:7], v245, s[38:39] offset:0 sc1
  v_exp_f32 v128, v128
  v_exp_f32 v129, v129
  v_exp_f32 v130, v130
  v_exp_f32 v131, v131
  v_cvt_pk_bf16_f32 v160, v128, v129
  v_cvt_pk_bf16_f32 v161, v130, v131
  v_mfma_f32_32x32x16_bf16 v[144:159], v[204:207], v[60:63], v[144:159]
  global_load_dwordx4 a[8:11], v244, s[38:39] offset:1024 sc1
  v_exp_f32 v132, v132
  v_exp_f32 v133, v133
  v_exp_f32 v134, v134
  v_exp_f32 v135, v135
  v_cvt_pk_bf16_f32 v162, v132, v133
  v_cvt_pk_bf16_f32 v163, v134, v135
  v_mfma_f32_32x32x16_bf16 v[80:95], v[212:215], v[164:167], v[80:95]
  global_load_dwordx4 a[12:15], v245, s[38:39] offset:1024 sc1
  v_exp_f32 v136, v136
  v_exp_f32 v137, v137
  v_exp_f32 v138, v138
  v_exp_f32 v139, v139
  v_cvt_pk_bf16_f32 v164, v136, v137
  v_cvt_pk_bf16_f32 v165, v138, v139
  v_mfma_f32_32x32x16_bf16 v[96:111], v[208:211], v[160:163], v[96:111]
  s_waitcnt vmcnt(21)
  v_exp_f32 v140, v140
  v_exp_f32 v141, v141
  v_exp_f32 v142, v142
  v_exp_f32 v143, v143
  v_cvt_pk_bf16_f32 v166, v140, v141
  v_cvt_pk_bf16_f32 v167, v142, v143
  v_mfma_f32_32x32x16_bf16 v[128:143], v[216:219], v[32:35], 0
  global_load_dwordx4 a[16:19], v244, s[38:39] offset:2048 sc1
  v_exp_f32 v144, v144
  v_exp_f32 v145, v145
  v_exp_f32 v146, v146
  v_exp_f32 v147, v147
  v_cvt_pk_bf16_f32 v160, v144, v145
  v_cvt_pk_bf16_f32 v161, v146, v147
  v_mfma_f32_32x32x16_bf16 v[128:143], v[220:223], v[36:39], v[128:143]
  global_load_dwordx4 a[20:23], v245, s[38:39] offset:2048 sc1
  v_exp_f32 v148, v148
  v_exp_f32 v149, v149
  v_exp_f32 v150, v150
  v_exp_f32 v151, v151
  v_cvt_pk_bf16_f32 v162, v148, v149
  v_cvt_pk_bf16_f32 v163, v150, v151
  v_mfma_f32_32x32x16_bf16 v[96:111], v[212:215], v[164:167], v[96:111]
  global_load_dwordx4 a[24:27], v244, s[38:39] offset:3072 sc1
  v_exp_f32 v152, v152
  v_exp_f32 v153, v153
  v_exp_f32 v154, v154
  v_exp_f32 v155, v155
  v_cvt_pk_bf16_f32 v164, v152, v153
  v_cvt_pk_bf16_f32 v165, v154, v155
  v_mfma_f32_32x32x16_bf16 v[112:127], v[208:211], v[160:163], v[112:127]
  global_load_dwordx4 a[28:31], v245, s[38:39] offset:3072 sc1
  v_exp_f32 v156, v156
  v_exp_f32 v157, v157
  v_exp_f32 v158, v158
  v_exp_f32 v159, v159
  v_cvt_pk_bf16_f32 v166, v156, v157
  v_cvt_pk_bf16_f32 v167, v158, v159
  v_mfma_f32_32x32x16_bf16 v[144:159], v[216:219], v[40:43], 0
  s_add_u32 s10, s10, 1
  s_cmp_eq_u32 s10, 7
  s_cselect_b32 s10, 0, s10
  v_exp_f32 v128, v128
  v_exp_f32 v129, v129
  v_exp_f32 v130, v130
  v_exp_f32 v131, v131
  v_cvt_pk_bf16_f32 v160, v128, v129
  v_cvt_pk_bf16_f32 v161, v130, v131
  v_mfma_f32_32x32x16_bf16 v[144:159], v[220:223], v[44:47], v[144:159]
  s_add_u32 s36, s36, 8192
  s_addc_u32 s37, s37, 0
  v_exp_f32 v132, v132
  v_exp_f32 v133, v133
  v_exp_f32 v134, v134
  v_exp_f32 v135, v135
  v_cvt_pk_bf16_f32 v162, v132, v133
  v_cvt_pk_bf16_f32 v163, v134, v135
  v_mfma_f32_32x32x16_bf16 v[112:127], v[212:215], v[164:167], v[112:127]
  s_lshl_b32 s11, s10, 12
  s_add_u32 s38, s4, s11
  s_addc_u32 s39, s5, 0
  v_exp_f32 v136, v136
  v_exp_f32 v137, v137
  v_exp_f32 v138, v138
  v_exp_f32 v139, v139
  v_cvt_pk_bf16_f32 v164, v136, v137
  v_cvt_pk_bf16_f32 v165, v138, v139
  v_mfma_f32_32x32x16_bf16 v[64:79], v[224:227], v[160:163], v[64:79]
  global_load_dwordx4 a[32:35], v244, s[38:39] offset:0 sc1
  v_exp_f32 v140, v140
  v_exp_f32 v141, v141
  v_exp_f32 v142, v142
  v_exp_f32 v143, v143
  v_cvt_pk_bf16_f32 v166, v140, v141
  v_cvt_pk_bf16_f32 v167, v142, v143
  v_mfma_f32_32x32x16_bf16 v[128:143], v[216:219], v[48:51], 0
  global_load_dwordx4 v[200:203], v2, s[36:37] offset:-4096 sc1
  v_exp_f32 v144, v144
  v_exp_f32 v145, v145
  v_exp_f32 v146, v146
  v_exp_f32 v147, v147
  v_cvt_pk_bf16_f32 v160, v144, v145
  v_cvt_pk_bf16_f32 v161, v146, v147
  v_mfma_f32_32x32x16_bf16 v[128:143], v[220:223], v[52:55], v[128:143]
  global_load_dwordx4 v[204:207], v2, s[36:37] offset:-3072 sc1
  v_exp_f32 v148, v148
  v_exp_f32 v149, v149
  v_exp_f32 v150, v150
  v_exp_f32 v151, v151
  v_cvt_pk_bf16_f32 v162, v148, v149
  v_cvt_pk_bf16_f32 v163, v150, v151
  v_mfma_f32_32x32x16_bf16 v[64:79], v[228:231], v[164:167], v[64:79]
  global_load_dwordx4 v[208:211], v2, s[36:37] offset:-2048 sc1
  v_exp_f32 v152, v152
  v_exp_f32 v153, v153
  v_exp_f32 v154, v154
  v_exp_f32 v155, v155
  v_cvt_pk_bf16_f32 v164, v152, v153
  v_cvt_pk_bf16_f32 v165, v154, v155
  v_mfma_f32_32x32x16_bf16 v[80:95], v[224:227], v[160:163], v[80:95]
  global_load_dwordx4 v[212:215], v2, s[36:37] offset:-1024 sc1
  v_exp_f32 v156, v156
  v_exp_f32 v157, v157
  v_exp_f32 v158, v158
  v_exp_f32 v159, v159
  v_cvt_pk_bf16_f32 v166, v156, v157
  v_cvt_pk_bf16_f32 v167, v158, v159
  v_mfma_f32_32x32x16_bf16 v[144:159], v[216:219], v[56:59], 0
  global_load_dwordx4 a[36:39], v245, s[38:39] offset:0 sc1
  v_exp_f32 v128, v128
  v_exp_f32 v129, v129
  v_exp_f32 v130, v130
  v_exp_f32 v131, v131
  v_cvt_pk_bf16_f32 v160, v128, v129
  v_cvt_pk_bf16_f32 v161, v130, v131
  v_mfma_f32_32x32x16_bf16 v[144:159], v[220:223], v[60:63], v[144:159]
  global_load_dwordx4 a[40:43], v244, s[38:39] offset:1024 sc1
  v_exp_f32 v132, v132
  v_exp_f32 v133, v133
  v_exp_f32 v134, v134
  v_exp_f32 v135, v135
  v_cvt_pk_bf16_f32 v162, v132, v133
  v_cvt_pk_bf16_f32 v163, v134, v135
  v_mfma_f32_32x32x16_bf16 v[80:95], v[228:231], v[164:167], v[80:95]
  global_load_dwordx4 a[44:47], v245, s[38:39] offset:1024 sc1
  v_exp_f32 v136, v136
  v_exp_f32 v137, v137
  v_exp_f32 v138, v138
  v_exp_f32 v139, v139
  v_cvt_pk_bf16_f32 v164, v136, v137
  v_cvt_pk_bf16_f32 v165, v138, v139
  v_mfma_f32_32x32x16_bf16 v[96:111], v[224:227], v[160:163], v[96:111]
  s_waitcnt vmcnt(24)
  v_exp_f32 v140, v140
  v_exp_f32 v141, v141
  v_exp_f32 v142, v142
  v_exp_f32 v143, v143
  v_cvt_pk_bf16_f32 v166, v140, v141
  v_cvt_pk_bf16_f32 v167, v142, v143
  v_mfma_f32_32x32x16_bf16 v[128:143], v[168:171], v[32:35], 0
  global_load_dwordx4 a[48:51], v244, s[38:39] offset:2048 sc1
  v_exp_f32 v144, v144
  v_exp_f32 v145, v145
  v_exp_f32 v146, v146
  v_exp_f32 v147, v147
  v_cvt_pk_bf16_f32 v160, v144, v145
  v_cvt_pk_bf16_f32 v161, v146, v147
  v_mfma_f32_32x32x16_bf16 v[128:143], v[172:175], v[36:39], v[128:143]
  global_load_dwordx4 a[52:55], v245, s[38:39] offset:2048 sc1
  v_exp_f32 v148, v148
  v_exp_f32 v149, v149
  v_exp_f32 v150, v150
  v_exp_f32 v151, v151
  v_cvt_pk_bf16_f32 v162, v148, v149
  v_cvt_pk_bf16_f32 v163, v150, v151
  v_mfma_f32_32x32x16_bf16 v[96:111], v[228:231], v[164:167], v[96:111]
  global_load_dwordx4 a[56:59], v244, s[38:39] offset:3072 sc1
  v_exp_f32 v152, v152
  v_exp_f32 v153, v153
  v_exp_f32 v154, v154
  v_exp_f32 v155, v155
  v_cvt_pk_bf16_f32 v164, v152, v153
  v_cvt_pk_bf16_f32 v165, v154, v155
  v_mfma_f32_32x32x16_bf16 v[112:127], v[224:227], v[160:163], v[112:127]
  global_load_dwordx4 a[60:63], v245, s[38:39] offset:3072 sc1
  v_exp_f32 v156, v156
  v_exp_f32 v157, v157
  v_exp_f32 v158, v158
  v_exp_f32 v159, v159
  v_cvt_pk_bf16_f32 v166, v156, v157
  v_cvt_pk_bf16_f32 v167, v158, v159
  v_mfma_f32_32x32x16_bf16 v[144:159], v[168:171], v[40:43], 0
  s_add_u32 s10, s10, 1
  s_cmp_eq_u32 s10, 7
  s_cselect_b32 s10, 0, s10
  v_exp_f32 v128, v128
  v_exp_f32 v129, v129
  v_exp_f32 v130, v130
  v_exp_f32 v131, v131
  v_cvt_pk_bf16_f32 v160, v128, v129
  v_cvt_pk_bf16_f32 v161, v130, v131
  v_mfma_f32_32x32x16_bf16 v[144:159], v[172:175], v[44:47], v[144:159]
  s_lshl_b32 s11, s10, 12
  s_add_u32 s38, s4, s11
  s_addc_u32 s39, s5, 0
  v_exp_f32 v132, v132
  v_exp_f32 v133, v133
  v_exp_f32 v134, v134
  v_exp_f32 v135, v135
  v_cvt_pk_bf16_f32 v162, v132, v133
  v_cvt_pk_bf16_f32 v163, v134, v135
  v_mfma_f32_32x32x16_bf16 v[112:127], v[228:231], v[164:167], v[112:127]
  global_load_dwordx4 a[64:67], v244, s[38:39] offset:0 sc1
  v_exp_f32 v136, v136
  v_exp_f32 v137, v137
  v_exp_f32 v138, v138
  v_exp_f32 v139, v139
  v_cvt_pk_bf16_f32 v164, v136, v137
  v_cvt_pk_bf16_f32 v165, v138, v139
  v_mfma_f32_32x32x16_bf16 v[64:79], v[176:179], v[160:163], v[64:79]
  global_load_dwordx4 a[68:71], v245, s[38:39] offset:0 sc1
  v_exp_f32 v140, v140
  v_exp_f32 v141, v141
  v_exp_f32 v142, v142
  v_exp_f32 v143, v143
  v_cvt_pk_bf16_f32 v166, v140, v141
  v_cvt_pk_bf16_f32 v167, v142, v143
  v_mfma_f32_32x32x16_bf16 v[128:143], v[168:171], v[48:51], 0
  global_load_dwordx4 v[216:219], v2, s[36:37] offset:0 sc1
  v_exp_f32 v144, v144
  v_exp_f32 v145, v145
  v_exp_f32 v146, v146
  v_exp_f32 v147, v147
  v_cvt_pk_bf16_f32 v160, v144, v145
  v_cvt_pk_bf16_f32 v161, v146, v147
  v_mfma_f32_32x32x16_bf16 v[128:143], v[172:175], v[52:55], v[128:143]
  global_load_dwordx4 v[220:223], v2, s[36:37] offset:1024 sc1
  v_exp_f32 v148, v148
  v_exp_f32 v149, v149
  v_exp_f32 v150, v150
  v_exp_f32 v151, v151
  v_cvt_pk_bf16_f32 v162, v148, v149
  v_cvt_pk_bf16_f32 v163, v150, v151
  v_mfma_f32_32x32x16_bf16 v[64:79], v[180:183], v[164:167], v[64:79]
  global_load_dwordx4 v[224:227], v2, s[36:37] offset:2048 sc1
  v_exp_f32 v152, v152
  v_exp_f32 v153, v153
  v_exp_f32 v154, v154
  v_exp_f32 v155, v155
  v_cvt_pk_bf16_f32 v164, v152, v153
  v_cvt_pk_bf16_f32 v165, v154, v155
  v_mfma_f32_32x32x16_bf16 v[80:95], v[176:179], v[160:163], v[80:95]
  global_load_dwordx4 v[228:231], v2, s[36:37] offset:3072 sc1
  v_exp_f32 v156, v156
  v_exp_f32 v157, v157
  v_exp_f32 v158, v158
  v_exp_f32 v159, v159
  v_cvt_pk_bf16_f32 v166, v156, v157
  v_cvt_pk_bf16_f32 v167, v158, v159
  v_mfma_f32_32x32x16_bf16 v[144:159], v[168:171], v[56:59], 0
  global_load_dwordx4 a[72:75], v244, s[38:39] offset:1024 sc1
  v_exp_f32 v128, v128
  v_exp_f32 v129, v129
  v_exp_f32 v130, v130
  v_exp_f32 v131, v131
  v_cvt_pk_bf16_f32 v160, v128, v129
  v_cvt_pk_bf16_f32 v161, v130, v131
  v_mfma_f32_32x32x16_bf16 v[144:159], v[172:175], v[60:63], v[144:159]
  global_load_dwordx4 a[76:79], v245, s[38:39] offset:1024 sc1
  v_exp_f32 v132, v132
  v_exp_f32 v133, v133
  v_exp_f32 v134, v134
  v_exp_f32 v135, v135
  v_cvt_pk_bf16_f32 v162, v132, v133
  v_cvt_pk_bf16_f32 v163, v134, v135
  v_mfma_f32_32x32x16_bf16 v[80:95], v[180:183], v[164:167], v[80:95]
  global_load_dwordx4 a[80:83], v244, s[38:39] offset:2048 sc1
  v_exp_f32 v136, v136
  v_exp_f32 v137, v137
  v_exp_f32 v138, v138
  v_exp_f32 v139, v139
  v_cvt_pk_bf16_f32 v164, v136, v137
  v_cvt_pk_bf16_f32 v165, v138, v139
  v_mfma_f32_32x32x16_bf16 v[96:111], v[176:179], v[160:163], v[96:111]
  s_waitcnt vmcnt(28)
  v_exp_f32 v140, v140
  v_exp_f32 v141, v141
  v_exp_f32 v142, v142
  v_exp_f32 v143, v143
  v_cvt_pk_bf16_f32 v166, v140, v141
  v_cvt_pk_bf16_f32 v167, v142, v143
  v_mfma_f32_32x32x16_bf16 v[128:143], v[184:187], v[32:35], 0
  global_load_dwordx4 a[84:87], v245, s[38:39] offset:2048 sc1
  v_exp_f32 v144, v144
  v_exp_f32 v145, v145
  v_exp_f32 v146, v146
  v_exp_f32 v147, v147
  v_cvt_pk_bf16_f32 v160, v144, v145
  v_cvt_pk_bf16_f32 v161, v146, v147
  v_mfma_f32_32x32x16_bf16 v[128:143], v[188:191], v[36:39], v[128:143]
  global_load_dwordx4 a[88:91], v244, s[38:39] offset:3072 sc1
  v_exp_f32 v148, v148
  v_exp_f32 v149, v149
  v_exp_f32 v150, v150
  v_exp_f32 v151, v151
  v_cvt_pk_bf16_f32 v162, v148, v149
  v_cvt_pk_bf16_f32 v163, v150, v151
  v_mfma_f32_32x32x16_bf16 v[96:111], v[180:183], v[164:167], v[96:111]
  global_load_dwordx4 a[92:95], v245, s[38:39] offset:3072 sc1
  v_exp_f32 v152, v152
  v_exp_f32 v153, v153
  v_exp_f32 v154, v154
  v_exp_f32 v155, v155
  v_cvt_pk_bf16_f32 v164, v152, v153
  v_cvt_pk_bf16_f32 v165, v154, v155
  v_mfma_f32_32x32x16_bf16 v[112:127], v[176:179], v[160:163], v[112:127]
  s_add_u32 s10, s10, 1
  s_cmp_eq_u32 s10, 7
  s_cselect_b32 s10, 0, s10
  v_exp_f32 v156, v156
  v_exp_f32 v157, v157
  v_exp_f32 v158, v158
  v_exp_f32 v159, v159
  v_cvt_pk_bf16_f32 v166, v156, v157
  v_cvt_pk_bf16_f32 v167, v158, v159
  v_mfma_f32_32x32x16_bf16 v[144:159], v[184:187], v[40:43], 0
  s_lshl_b32 s11, s10, 12
  s_add_u32 s38, s4, s11
  s_addc_u32 s39, s5, 0
  v_exp_f32 v128, v128
  v_exp_f32 v129, v129
  v_exp_f32 v130, v130
  v_exp_f32 v131, v131
  v_cvt_pk_bf16_f32 v160, v128, v129
  v_cvt_pk_bf16_f32 v161, v130, v131
  v_mfma_f32_32x32x16_bf16 v[144:159], v[188:191], v[44:47], v[144:159]
  global_load_dwordx4 a[96:99], v244, s[38:39] offset:0 sc1
  v_exp_f32 v132, v132
  v_exp_f32 v133, v133
  v_exp_f32 v134, v134
  v_exp_f32 v135, v135
  v_cvt_pk_bf16_f32 v162, v132, v133
  v_cvt_pk_bf16_f32 v163, v134, v135
  v_mfma_f32_32x32x16_bf16 v[112:127], v[180:183], v[164:167], v[112:127]
  global_load_dwordx4 a[100:103], v245, s[38:39] offset:0 sc1
  v_exp_f32 v136, v136
  v_exp_f32 v137, v137
  v_exp_f32 v138, v138
  v_exp_f32 v139, v139
  v_cvt_pk_bf16_f32 v164, v136, v137
  v_cvt_pk_bf16_f32 v165, v138, v139
  v_mfma_f32_32x32x16_bf16 v[64:79], v[192:195], v[160:163], v[64:79]
  global_load_dwordx4 a[104:107], v244, s[38:39] offset:1024 sc1
  v_exp_f32 v140, v140
  v_exp_f32 v141, v141
  v_exp_f32 v142, v142
  v_exp_f32 v143, v143
  v_cvt_pk_bf16_f32 v166, v140, v141
  v_cvt_pk_bf16_f32 v167, v142, v143
  v_mfma_f32_32x32x16_bf16 v[128:143], v[184:187], v[48:51], 0
  global_load_dwordx4 a[108:111], v245, s[38:39] offset:1024 sc1
  v_exp_f32 v144, v144
  v_exp_f32 v145, v145
  v_exp_f32 v146, v146
  v_exp_f32 v147, v147
  v_cvt_pk_bf16_f32 v160, v144, v145
  v_cvt_pk_bf16_f32 v161, v146, v147
  v_mfma_f32_32x32x16_bf16 v[128:143], v[188:191], v[52:55], v[128:143]
  global_load_dwordx4 a[112:115], v244, s[38:39] offset:2048 sc1
  v_exp_f32 v148, v148
  v_exp_f32 v149, v149
  v_exp_f32 v150, v150
  v_exp_f32 v151, v151
  v_cvt_pk_bf16_f32 v162, v148, v149
  v_cvt_pk_bf16_f32 v163, v150, v151
  v_mfma_f32_32x32x16_bf16 v[64:79], v[196:199], v[164:167], v[64:79]
  global_load_dwordx4 a[116:119], v245, s[38:39] offset:2048 sc1
  v_exp_f32 v152, v152
  v_exp_f32 v153, v153
  v_exp_f32 v154, v154
  v_exp_f32 v155, v155
  v_cvt_pk_bf16_f32 v164, v152, v153
  v_cvt_pk_bf16_f32 v165, v154, v155
  v_mfma_f32_32x32x16_bf16 v[80:95], v[192:195], v[160:163], v[80:95]
  global_load_dwordx4 a[120:123], v244, s[38:39] offset:3072 sc1
  v_exp_f32 v156, v156
  v_exp_f32 v157, v157
  v_exp_f32 v158, v158
  v_exp_f32 v159, v159
  v_cvt_pk_bf16_f32 v166, v156, v157
  v_cvt_pk_bf16_f32 v167, v158, v159
  v_mfma_f32_32x32x16_bf16 v[144:159], v[184:187], v[56:59], 0
  global_load_dwordx4 a[124:127], v245, s[38:39] offset:3072 sc1
  v_exp_f32 v128, v128
  v_exp_f32 v129, v129
  v_exp_f32 v130, v130
  v_exp_f32 v131, v131
  v_cvt_pk_bf16_f32 v160, v128, v129
  v_cvt_pk_bf16_f32 v161, v130, v131
  v_mfma_f32_32x32x16_bf16 v[144:159], v[188:191], v[60:63], v[144:159]
  s_add_u32 s10, s10, 1
  s_cmp_eq_u32 s10, 7
  s_cselect_b32 s10, 0, s10
  v_exp_f32 v132, v132
  v_exp_f32 v133, v133
  v_exp_f32 v134, v134
  v_exp_f32 v135, v135
  v_cvt_pk_bf16_f32 v162, v132, v133
  v_cvt_pk_bf16_f32 v163, v134, v135
  v_mfma_f32_32x32x16_bf16 v[80:95], v[196:199], v[164:167], v[80:95]
  s_lshl_b32 s11, s10, 12
  s_add_u32 s38, s4, s11
  s_addc_u32 s39, s5, 0
  v_exp_f32 v136, v136
  v_exp_f32 v137, v137
  v_exp_f32 v138, v138
  v_exp_f32 v139, v139
  v_cvt_pk_bf16_f32 v164, v136, v137
  v_cvt_pk_bf16_f32 v165, v138, v139
  v_mfma_f32_32x32x16_bf16 v[96:111], v[192:195], v[160:163], v[96:111]
  s_waitcnt vmcnt(27)
  v_exp_f32 v140, v140
  v_exp_f32 v141, v141
  v_exp_f32 v142, v142
  v_exp_f32 v143, v143
  v_cvt_pk_bf16_f32 v166, v140, v141
  v_cvt_pk_bf16_f32 v167, v142, v143
  v_mfma_f32_32x32x16_bf16 v[128:143], v[200:203], v[32:35], 0
  global_load_dwordx4 a[128:131], v244, s[38:39] offset:0 sc1
  v_exp_f32 v144, v144
  v_exp_f32 v145, v145
  v_exp_f32 v146, v146
  v_exp_f32 v147, v147
  v_cvt_pk_bf16_f32 v160, v144, v145
  v_cvt_pk_bf16_f32 v161, v146, v147
  v_mfma_f32_32x32x16_bf16 v[128:143], v[204:207], v[36:39], v[128:143]
  global_load_dwordx4 a[132:135], v245, s[38:39] offset:0 sc1
  v_exp_f32 v148, v148
  v_exp_f32 v149, v149
  v_exp_f32 v150, v150
  v_exp_f32 v151, v151
  v_cvt_pk_bf16_f32 v162, v148, v149
  v_cvt_pk_bf16_f32 v163, v150, v151
  v_mfma_f32_32x32x16_bf16 v[96:111], v[196:199], v[164:167], v[96:111]
  global_load_dwordx4 a[136:139], v244, s[38:39] offset:1024 sc1
  v_exp_f32 v152, v152
  v_exp_f32 v153, v153
  v_exp_f32 v154, v154
  v_exp_f32 v155, v155
  v_cvt_pk_bf16_f32 v164, v152, v153
  v_cvt_pk_bf16_f32 v165, v154, v155
  v_mfma_f32_32x32x16_bf16 v[112:127], v[192:195], v[160:163], v[112:127]
  global_load_dwordx4 a[140:143], v245, s[38:39] offset:1024 sc1
  v_exp_f32 v156, v156
  v_exp_f32 v157, v157
  v_exp_f32 v158, v158
  v_exp_f32 v159, v159
  v_cvt_pk_bf16_f32 v166, v156, v157
  v_cvt_pk_bf16_f32 v167, v158, v159
  v_mfma_f32_32x32x16_bf16 v[144:159], v[200:203], v[40:43], 0
  global_load_dwordx4 a[144:147], v244, s[38:39] offset:2048 sc1
  v_exp_f32 v128, v128
  v_exp_f32 v129, v129
  v_exp_f32 v130, v130
  v_exp_f32 v131, v131
  v_cvt_pk_bf16_f32 v160, v128, v129
  v_cvt_pk_bf16_f32 v161, v130, v131
  v_mfma_f32_32x32x16_bf16 v[144:159], v[204:207], v[44:47], v[144:159]
  global_load_dwordx4 a[148:151], v245, s[38:39] offset:2048 sc1
  v_exp_f32 v132, v132
  v_exp_f32 v133, v133
  v_exp_f32 v134, v134
  v_exp_f32 v135, v135
  v_cvt_pk_bf16_f32 v162, v132, v133
  v_cvt_pk_bf16_f32 v163, v134, v135
  v_mfma_f32_32x32x16_bf16 v[112:127], v[196:199], v[164:167], v[112:127]
  global_load_dwordx4 a[152:155], v244, s[38:39] offset:3072 sc1
  v_exp_f32 v136, v136
  v_exp_f32 v137, v137
  v_exp_f32 v138, v138
  v_exp_f32 v139, v139
  v_cvt_pk_bf16_f32 v164, v136, v137
  v_cvt_pk_bf16_f32 v165, v138, v139
  v_mfma_f32_32x32x16_bf16 v[64:79], v[208:211], v[160:163], v[64:79]
  global_load_dwordx4 a[156:159], v245, s[38:39] offset:3072 sc1
  v_exp_f32 v140, v140
  v_exp_f32 v141, v141
  v_exp_f32 v142, v142
  v_exp_f32 v143, v143
  v_cvt_pk_bf16_f32 v166, v140, v141
  v_cvt_pk_bf16_f32 v167, v142, v143
  v_mfma_f32_32x32x16_bf16 v[128:143], v[200:203], v[48:51], 0
  s_add_u32 s10, s10, 1
  s_cmp_eq_u32 s10, 7
  s_cselect_b32 s10, 0, s10
  v_exp_f32 v144, v144
  v_exp_f32 v145, v145
  v_exp_f32 v146, v146
  v_exp_f32 v147, v147
  v_cvt_pk_bf16_f32 v160, v144, v145
  v_cvt_pk_bf16_f32 v161, v146, v147
  v_mfma_f32_32x32x16_bf16 v[128:143], v[204:207], v[52:55], v[128:143]
  s_lshl_b32 s11, s10, 12
  s_add_u32 s38, s4, s11
  s_addc_u32 s39, s5, 0
  v_exp_f32 v148, v148
  v_exp_f32 v149, v149
  v_exp_f32 v150, v150
  v_exp_f32 v151, v151
  v_cvt_pk_bf16_f32 v162, v148, v149
  v_cvt_pk_bf16_f32 v163, v150, v151
  v_mfma_f32_32x32x16_bf16 v[64:79], v[212:215], v[164:167], v[64:79]
  global_load_dwordx4 a[160:163], v244, s[38:39] offset:0 sc1
  v_exp_f32 v152, v152
  v_exp_f32 v153, v153
  v_exp_f32 v154, v154
  v_exp_f32 v155, v155
  v_cvt_pk_bf16_f32 v164, v152, v153
  v_cvt_pk_bf16_f32 v165, v154, v155
  v_mfma_f32_32x32x16_bf16 v[80:95], v[208:211], v[160:163], v[80:95]
  global_load_dwordx4 a[164:167], v245, s[38:39] offset:0 sc1
  v_exp_f32 v156, v156
  v_exp_f32 v157, v157
  v_exp_f32 v158, v158
  v_exp_f32 v159, v159
  v_cvt_pk_bf16_f32 v166, v156, v157
  v_cvt_pk_bf16_f32 v167, v158, v159
  v_mfma_f32_32x32x16_bf16 v[144:159], v[200:203], v[56:59], 0
  global_load_dwordx4 a[168:171], v244, s[38:39] offset:1024 sc1
  v_exp_f32 v128, v128
  v_exp_f32 v129, v129
  v_exp_f32 v130, v130
  v_exp_f32 v131, v131
  v_cvt_pk_bf16_f32 v160, v128, v129
  v_cvt_pk_bf16_f32 v161, v130, v131
  v_mfma_f32_32x32x16_bf16 v[144:159], v[204:207], v[60:63], v[144:159]
  global_load_dwordx4 a[172:175], v245, s[38:39] offset:1024 sc1
  v_exp_f32 v132, v132
  v_exp_f32 v133, v133
  v_exp_f32 v134, v134
  v_exp_f32 v135, v135
  v_cvt_pk_bf16_f32 v162, v132, v133
  v_cvt_pk_bf16_f32 v163, v134, v135
  v_mfma_f32_32x32x16_bf16 v[80:95], v[212:215], v[164:167], v[80:95]
  global_load_dwordx4 a[176:179], v244, s[38:39] offset:2048 sc1
  v_exp_f32 v136, v136
  v_exp_f32 v137, v137
  v_exp_f32 v138, v138
  v_exp_f32 v139, v139
  v_cvt_pk_bf16_f32 v164, v136, v137
  v_cvt_pk_bf16_f32 v165, v138, v139
  v_mfma_f32_32x32x16_bf16 v[96:111], v[208:211], v[160:163], v[96:111]
  s_waitcnt vmcnt(27)
  v_exp_f32 v140, v140
  v_exp_f32 v141, v141
  v_exp_f32 v142, v142
  v_exp_f32 v143, v143
  v_cvt_pk_bf16_f32 v166, v140, v141
  v_cvt_pk_bf16_f32 v167, v142, v143
  v_mfma_f32_32x32x16_bf16 v[128:143], v[216:219], v[32:35], 0
  global_load_dwordx4 a[180:183], v245, s[38:39] offset:2048 sc1
  v_exp_f32 v144, v144
  v_exp_f32 v145, v145
  v_exp_f32 v146, v146
  v_exp_f32 v147, v147
  v_cvt_pk_bf16_f32 v160, v144, v145
  v_cvt_pk_bf16_f32 v161, v146, v147
  v_mfma_f32_32x32x16_bf16 v[128:143], v[220:223], v[36:39], v[128:143]
  global_load_dwordx4 a[184:187], v244, s[38:39] offset:3072 sc1
  v_exp_f32 v148, v148
  v_exp_f32 v149, v149
  v_exp_f32 v150, v150
  v_exp_f32 v151, v151
  v_cvt_pk_bf16_f32 v162, v148, v149
  v_cvt_pk_bf16_f32 v163, v150, v151
  v_mfma_f32_32x32x16_bf16 v[96:111], v[212:215], v[164:167], v[96:111]
  global_load_dwordx4 a[188:191], v245, s[38:39] offset:3072 sc1
  v_exp_f32 v152, v152
  v_exp_f32 v153, v153
  v_exp_f32 v154, v154
  v_exp_f32 v155, v155
  v_cvt_pk_bf16_f32 v164, v152, v153
  v_cvt_pk_bf16_f32 v165, v154, v155
  v_mfma_f32_32x32x16_bf16 v[112:127], v[208:211], v[160:163], v[112:127]
  s_add_u32 s10, s10, 1
  s_cmp_eq_u32 s10, 7
  s_cselect_b32 s10, 0, s10
  v_exp_f32 v156, v156
  v_exp_f32 v157, v157
  v_exp_f32 v158, v158
  v_exp_f32 v159, v159
  v_cvt_pk_bf16_f32 v166, v156, v157
  v_cvt_pk_bf16_f32 v167, v158, v159
  v_mfma_f32_32x32x16_bf16 v[144:159], v[216:219], v[40:43], 0
  s_lshl_b32 s11, s10, 12
  s_add_u32 s38, s4, s11
  s_addc_u32 s39, s5, 0
  v_exp_f32 v128, v128
  v_exp_f32 v129, v129
  v_exp_f32 v130, v130
  v_exp_f32 v131, v131
  v_cvt_pk_bf16_f32 v160, v128, v129
  v_cvt_pk_bf16_f32 v161, v130, v131
  v_mfma_f32_32x32x16_bf16 v[144:159], v[220:223], v[44:47], v[144:159]
  global_load_dwordx4 a[192:195], v244, s[38:39] offset:0 sc1
  v_exp_f32 v132, v132
  v_exp_f32 v133, v133
  v_exp_f32 v134, v134
  v_exp_f32 v135, v135
  v_cvt_pk_bf16_f32 v162, v132, v133
  v_cvt_pk_bf16_f32 v163, v134, v135
  v_mfma_f32_32x32x16_bf16 v[112:127], v[212:215], v[164:167], v[112:127]
  global_load_dwordx4 a[196:199], v245, s[38:39] offset:0 sc1
  v_exp_f32 v136, v136
  v_exp_f32 v137, v137
  v_exp_f32 v138, v138
  v_exp_f32 v139, v139
  v_cvt_pk_bf16_f32 v164, v136, v137
  v_cvt_pk_bf16_f32 v165, v138, v139
  v_mfma_f32_32x32x16_bf16 v[64:79], v[224:227], v[160:163], v[64:79]
  global_load_dwordx4 a[200:203], v244, s[38:39] offset:1024 sc1
  v_exp_f32 v140, v140
  v_exp_f32 v141, v141
  v_exp_f32 v142, v142
  v_exp_f32 v143, v143
  v_cvt_pk_bf16_f32 v166, v140, v141
  v_cvt_pk_bf16_f32 v167, v142, v143
  v_mfma_f32_32x32x16_bf16 v[128:143], v[216:219], v[48:51], 0
  global_load_dwordx4 a[204:207], v245, s[38:39] offset:1024 sc1
  v_exp_f32 v144, v144
  v_exp_f32 v145, v145
  v_exp_f32 v146, v146
  v_exp_f32 v147, v147
  v_cvt_pk_bf16_f32 v160, v144, v145
  v_cvt_pk_bf16_f32 v161, v146, v147
  v_mfma_f32_32x32x16_bf16 v[128:143], v[220:223], v[52:55], v[128:143]
  global_load_dwordx4 a[208:211], v244, s[38:39] offset:2048 sc1
  v_exp_f32 v148, v148
  v_exp_f32 v149, v149
  v_exp_f32 v150, v150
  v_exp_f32 v151, v151
  v_cvt_pk_bf16_f32 v162, v148, v149
  v_cvt_pk_bf16_f32 v163, v150, v151
  v_mfma_f32_32x32x16_bf16 v[64:79], v[228:231], v[164:167], v[64:79]
  global_load_dwordx4 a[212:215], v245, s[38:39] offset:2048 sc1
  v_exp_f32 v152, v152
  v_exp_f32 v153, v153
  v_exp_f32 v154, v154
  v_exp_f32 v155, v155
  v_cvt_pk_bf16_f32 v164, v152, v153
  v_cvt_pk_bf16_f32 v165, v154, v155
  v_mfma_f32_32x32x16_bf16 v[80:95], v[224:227], v[160:163], v[80:95]
  global_load_dwordx4 a[216:219], v244, s[38:39] offset:3072 sc1
  v_exp_f32 v156, v156
  v_exp_f32 v157, v157
  v_exp_f32 v158, v158
  v_exp_f32 v159, v159
  v_cvt_pk_bf16_f32 v166, v156, v157
  v_cvt_pk_bf16_f32 v167, v158, v159
  v_mfma_f32_32x32x16_bf16 v[144:159], v[216:219], v[56:59], 0
  global_load_dwordx4 a[220:223], v245, s[38:39] offset:3072 sc1
  v_exp_f32 v128, v128
  v_exp_f32 v129, v129
  v_exp_f32 v130, v130
  v_exp_f32 v131, v131
  v_cvt_pk_bf16_f32 v160, v128, v129
  v_cvt_pk_bf16_f32 v161, v130, v131
  v_mfma_f32_32x32x16_bf16 v[144:159], v[220:223], v[60:63], v[144:159]
  v_exp_f32 v132, v132
  v_exp_f32 v133, v133
  v_exp_f32 v134, v134
  v_exp_f32 v135, v135
  v_cvt_pk_bf16_f32 v162, v132, v133
  v_cvt_pk_bf16_f32 v163, v134, v135
  v_mfma_f32_32x32x16_bf16 v[80:95], v[228:231], v[164:167], v[80:95]
  v_exp_f32 v136, v136
  v_exp_f32 v137, v137
  v_exp_f32 v138, v138
  v_exp_f32 v139, v139
  v_cvt_pk_bf16_f32 v164, v136, v137
  v_cvt_pk_bf16_f32 v165, v138, v139
  v_mfma_f32_32x32x16_bf16 v[96:111], v[224:227], v[160:163], v[96:111]
  v_exp_f32 v140, v140
  v_exp_f32 v141, v141
  v_exp_f32 v142, v142
  v_exp_f32 v143, v143
  v_cvt_pk_bf16_f32 v166, v140, v141
  v_cvt_pk_bf16_f32 v167, v142, v143
  v_exp_f32 v144, v144
  v_exp_f32 v145, v145
  v_exp_f32 v146, v146
  v_exp_f32 v147, v147
  v_cvt_pk_bf16_f32 v160, v144, v145
  v_cvt_pk_bf16_f32 v161, v146, v147
  v_exp_f32 v148, v148
  v_exp_f32 v149, v149
  v_exp_f32 v150, v150
  v_exp_f32 v151, v151
  v_cvt_pk_bf16_f32 v162, v148, v149
  v_cvt_pk_bf16_f32 v163, v150, v151
  v_mfma_f32_32x32x16_bf16 v[96:111], v[228:231], v[164:167], v[96:111]
  v_exp_f32 v152, v152
  v_exp_f32 v153, v153
  v_exp_f32 v154, v154
  v_exp_f32 v155, v155
  v_cvt_pk_bf16_f32 v164, v152, v153
  v_cvt_pk_bf16_f32 v165, v154, v155
  v_mfma_f32_32x32x16_bf16 v[112:127], v[224:227], v[160:163], v[112:127]
  v_exp_f32 v156, v156
  v_exp_f32 v157, v157
  v_exp_f32 v158, v158
  v_exp_f32 v159, v159
  v_cvt_pk_bf16_f32 v166, v156, v157
  v_cvt_pk_bf16_f32 v167, v158, v159
  s_nop 1
  v_mfma_f32_32x32x16_bf16 v[112:127], v[228:231], v[164:167], v[112:127]
  v_mfma_f32_32x32x16_bf16 v[176:191], a[228:231], a[4:7], 0
  ds_read_b64_tr_b16 v[192:193], v26 offset:12288
  ds_write_b128 v253, v[80:83] offset:0
  v_mfma_f32_32x32x16_bf16 v[160:175], a[224:227], a[4:7], 0
  ds_read_b64_tr_b16 v[194:195], v26 offset:13312
  ds_write_b128 v253, v[84:87] offset:1024
  v_mfma_f32_32x32x16_bf16 v[144:159], a[228:231], a[0:3], 0
  ds_read_b64_tr_b16 v[196:197], v27 offset:12288
  ds_write_b128 v253, v[88:91] offset:2048
  v_mfma_f32_32x32x16_bf16 v[128:143], a[224:227], a[0:3], 0
  ds_read_b64_tr_b16 v[198:199], v27 offset:13312
  ds_write_b128 v254, v[96:99] offset:0
  v_add_f32 v7, v76, v92
  v_add_f32 v7, v7, v108
  v_add_f32 v7, v7, v124
  v_cmp_ngt_f32 vcc, 0x53800000, v7
  s_and_b64 vcc, vcc, s[66:67]
  s_cselect_b32 s53, 1.0, 0
  v_mov_b32 v7, s53
  v_mfma_f32_32x32x16_bf16 v[176:191], a[236:239], a[12:15], v[176:191]
  ds_read_b64_tr_b16 v[200:201], v26 offset:14336
  ds_write_b128 v254, v[100:103] offset:1024
  v_cndmask_b32 v79, v79, v7, s[66:67]
  v_cndmask_b32 v95, v95, v7, s[66:67]
  v_cndmask_b32 v111, v111, v7, s[66:67]
  v_cndmask_b32 v127, v127, v7, s[66:67]
  v_mfma_f32_32x32x16_bf16 v[160:175], a[232:235], a[12:15], v[160:175]
  ds_read_b64_tr_b16 v[202:203], v26 offset:15360
  ds_write_b128 v254, v[104:107] offset:2048
  v_mfma_f32_32x32x16_bf16 v[144:159], a[236:239], a[8:11], v[144:159]
  ds_read_b64_tr_b16 v[204:205], v27 offset:14336
  ds_write_b128 v253, v[92:95] offset:3072
  v_mfma_f32_32x32x16_bf16 v[128:143], a[232:235], a[8:11], v[128:143]
  ds_read_b64_tr_b16 v[206:207], v27 offset:15360
  ds_write_b128 v254, v[108:111] offset:3072
  v_mfma_f32_32x32x16_bf16 v[176:191], a[244:247], a[20:23], v[176:191]
  ds_read_b64_tr_b16 v[208:209], v26 offset:16384
  ds_write_b128 v255, v[112:115] offset:0
  s_add_u32 m0, s47, 12288
  v_mfma_f32_32x32x16_bf16 v[160:175], a[240:243], a[20:23], v[160:175]
  ds_read_b64_tr_b16 v[210:211], v26 offset:17408
  ds_write_b128 v255, v[116:119] offset:1024
  s_add_u32 s8, s8, 1
  v_mfma_f32_32x32x16_bf16 v[144:159], a[244:247], a[16:19], v[144:159]
  ds_read_b64_tr_b16 v[212:213], v27 offset:16384
  ds_write_b128 v255, v[120:123] offset:2048
  s_cmp_eq_u32 s8, 7
  s_cselect_b32 s8, 0, s8
  v_mfma_f32_32x32x16_bf16 v[128:143], a[240:243], a[16:19], v[128:143]
  ds_read_b64_tr_b16 v[214:215], v27 offset:17408
  ds_write_b128 v255, v[124:127] offset:3072
  s_mul_i32 s9, s8, 57344
  v_mfma_f32_32x32x16_bf16 v[176:191], a[252:255], a[28:31], v[176:191]
  ds_read_b64_tr_b16 v[216:217], v26 offset:18432
  s_waitcnt lgkmcnt(1)
  s_barrier
  s_add_u32 s40, s6, s9
  s_addc_u32 s41, s7, 0
  v_mfma_f32_32x32x16_bf16 v[160:175], a[248:251], a[28:31], v[160:175]
  ds_read_b64_tr_b16 v[218:219], v26 offset:19456
  ds_read_b128 v[80:83], v252 offset:0
  ds_read_b128 v[84:87], v252 offset:1024
  v_mfma_f32_32x32x16_bf16 v[144:159], a[252:255], a[24:27], v[144:159]
  ds_read_b64_tr_b16 v[220:221], v27 offset:18432
  ds_read_b128 v[88:91], v252 offset:2048
  ds_read_b128 v[92:95], v252 offset:3072
  global_load_lds_dwordx4 v240, s[40:41] offset:0
  v_mfma_f32_32x32x16_bf16 v[128:143], a[248:251], a[24:27], v[128:143]
  ds_read_b64_tr_b16 v[222:223], v27 offset:19456
  ds_read_b128 v[96:99], v252 offset:4096
  ds_read_b128 v[100:103], v252 offset:5120
  global_load_lds_dwordx4 v241, s[40:41] offset:1024
  v_mfma_f32_32x32x16_bf16 v[176:191], v[12:15], a[36:39], v[176:191]
  ds_read_b64_tr_b16 v[224:225], v26 offset:20480
  ds_read_b128 v[104:107], v252 offset:6144
  ds_read_b128 v[108:111], v252 offset:7168
  global_load_lds_dwordx4 v242, s[40:41] offset:2048
  v_mfma_f32_32x32x16_bf16 v[160:175], v[8:11], a[36:39], v[160:175]
  ds_read_b64_tr_b16 v[226:227], v26 offset:21504
  ds_read_b128 v[112:115], v252 offset:8192
  ds_read_b128 v[116:119], v252 offset:9216
  global_load_lds_dwordx4 v243, s[40:41] offset:3072
  v_mfma_f32_32x32x16_bf16 v[144:159], v[12:15], a[32:35], v[144:159]
  ds_read_b64_tr_b16 v[228:229], v27 offset:20480
  ds_read_b128 v[120:123], v252 offset:10240
  ds_read_b128 v[124:127], v252 offset:11264
  s_add_u32 m0, s47, 16384
  v_mfma_f32_32x32x16_bf16 v[128:143], v[8:11], a[32:35], v[128:143]
  ds_read_b64_tr_b16 v[230:231], v27 offset:21504
  s_waitcnt lgkmcnt(13)
  v_add_f32 v76, v76, v92
  v_add_f32 v79, v79, v95
  v_add_f32 v77, v77, v93
  v_add_f32 v78, v78, v94
  v_add_f32 v64, v64, v80
  s_add_u32 s40, s40, 28672
  s_addc_u32 s41, s41, 0
  v_mfma_f32_32x32x16_bf16 v[176:191], v[20:23], a[44:47], v[176:191]
  v_add_f32 v65, v65, v81
  v_add_f32 v66, v66, v82
  v_add_f32 v67, v67, v83
  v_add_f32 v68, v68, v84
  v_add_f32 v69, v69, v85
  v_add_f32 v70, v70, v86
  s_waitcnt lgkmcnt(12)
  v_mfma_f32_32x32x16_bf16 v[160:175], v[16:19], a[44:47], v[160:175]
  v_add_f32 v71, v71, v87
  v_add_f32 v72, v72, v88
  v_add_f32 v73, v73, v89
  v_add_f32 v74, v74, v90
  v_add_f32 v75, v75, v91
  s_waitcnt lgkmcnt(7)
  global_load_lds_dwordx4 v240, s[40:41] offset:0
  v_mfma_f32_32x32x16_bf16 v[144:159], v[20:23], a[40:43], v[144:159]
  v_add_f32 v76, v76, v108
  v_add_f32 v79, v79, v111
  v_add_f32 v77, v77, v109
  v_add_f32 v78, v78, v110
  v_add_f32 v64, v64, v96
  v_add_f32 v65, v65, v97
  global_load_lds_dwordx4 v241, s[40:41] offset:1024
  v_mfma_f32_32x32x16_bf16 v[128:143], v[16:19], a[40:43], v[128:143]
  v_add_f32 v66, v66, v98
  v_add_f32 v67, v67, v99
  v_add_f32 v68, v68, v100
  v_add_f32 v69, v69, v101
  v_add_f32 v70, v70, v102
  v_add_f32 v71, v71, v103
  global_load_lds_dwordx4 v242, s[40:41] offset:2048
  v_mfma_f32_32x32x16_bf16 v[176:191], v[196:199], a[52:55], v[176:191]
  v_add_f32 v72, v72, v104
  v_add_f32 v73, v73, v105
  v_add_f32 v74, v74, v106
  v_add_f32 v75, v75, v107
  s_waitcnt lgkmcnt(1)
  v_add_f32 v76, v76, v124
  global_load_lds_dwordx4 v243, s[40:41] offset:3072
  v_mfma_f32_32x32x16_bf16 v[160:175], v[192:195], a[52:55], v[160:175]
  v_add_f32 v79, v79, v127
  v_add_f32 v77, v77, v125
  v_add_f32 v78, v78, v126
  v_add_f32 v64, v64, v112
  v_add_f32 v65, v65, v113
  v_add_f32 v66, v66, v114
  v_mfma_f32_32x32x16_bf16 v[144:159], v[196:199], a[48:51], v[144:159]
  v_add_f32 v67, v67, v115
  v_add_f32 v68, v68, v116
  v_add_f32 v69, v69, v117
  v_add_f32 v70, v70, v118
  v_add_f32 v71, v71, v119
  v_add_f32 v72, v72, v120
  v_mfma_f32_32x32x16_bf16 v[128:143], v[192:195], a[48:51], v[128:143]
  v_add_f32 v73, v73, v121
  v_add_f32 v74, v74, v122
  v_add_f32 v75, v75, v123
  v_readlane_b32 s52, v79, 32
  v_rcp_f32 v3, v76
  s_cmp_lg_u32 s52, 0
  s_cbranch_scc1 L_fb
L_fbok:
  v_mul_f32 v3, v3, v29
  v_mfma_f32_32x32x16_bf16 v[176:191], v[204:207], a[60:63], v[176:191]
  ds_read_b64_tr_b16 v[192:193], v26 offset:22528
  v_mov_b32 v4, v3
  s_nop 1
  v_permlane32_swap_b32 v3, v4
  s_nop 1
  v_mul_f32 v64, v4, v64
  v_mul_f32 v65, v4, v65
  v_mul_f32 v66, v4, v66
  v_mul_f32 v67, v4, v67
  v_mul_f32 v68, v4, v68
  v_mfma_f32_32x32x16_bf16 v[160:175], v[200:203], a[60:63], v[160:175]
  ds_read_b64_tr_b16 v[194:195], v26 offset:23552
  v_mul_f32 v69, v4, v69
  v_mul_f32 v70, v4, v70
  v_mul_f32 v71, v4, v71
  v_mul_f32 v72, v4, v72
  v_mul_f32 v73, v4, v73
  v_mul_f32 v74, v4, v74
  v_mfma_f32_32x32x16_bf16 v[144:159], v[204:207], a[56:59], v[144:159]
  ds_read_b64_tr_b16 v[196:197], v27 offset:22528
  v_mul_f32 v75, v4, v75
  v_mul_f32 v76, v4, v76
  v_mul_f32 v77, v4, v77
  v_mul_f32 v78, v4, v78
  v_mul_f32 v79, v4, v79
  v_cvt_pk_bf16_f32 v32, v64, v65
  v_mfma_f32_32x32x16_bf16 v[128:143], v[200:203], a[56:59], v[128:143]
  ds_read_b64_tr_b16 v[198:199], v27 offset:23552
  v_cvt_pk_bf16_f32 v33, v66, v67
  v_cvt_pk_bf16_f32 v34, v68, v69
  v_cvt_pk_bf16_f32 v35, v70, v71
  v_cvt_pk_bf16_f32 v36, v72, v73
  v_cvt_pk_bf16_f32 v37, v74, v75
  v_cvt_pk_bf16_f32 v38, v76, v77
  v_mfma_f32_32x32x16_bf16 v[176:191], v[212:215], a[68:71], v[176:191]
  ds_read_b64_tr_b16 v[200:201], v26 offset:24576
  v_cvt_pk_bf16_f32 v39, v78, v79
  v_cndmask_b32 v38, v38, 0, s[66:67]
  v_cndmask_b32 v39, v39, 0, s[66:67]
  buffer_store_dwordx4 v[32:35], v2, s[20:23], s68 offen offset:0 sc1
  buffer_store_dwordx4 v[36:39], v2, s[20:23], s68 offen offset:1024 sc1
  s_cmp_eq_u32 s65, 7
  s_cbranch_scc1 L_idle
  s_add_u32 m0, s47, 20480
  s_add_u32 s8, s8, 1
  v_mfma_f32_32x32x16_bf16 v[160:175], v[208:211], a[68:71], v[160:175]
  ds_read_b64_tr_b16 v[202:203], v26 offset:25600
  ds_read_b64_tr_b16 v[204:205], v27 offset:24576
  s_cmp_eq_u32 s8, 7
  s_cselect_b32 s8, 0, s8
  s_mul_i32 s9, s8, 57344
  v_mfma_f32_32x32x16_bf16 v[144:159], v[212:215], a[64:67], v[144:159]
  ds_read_b64_tr_b16 v[206:207], v27 offset:25600
  s_add_u32 s40, s6, s9
  s_addc_u32 s41, s7, 0
  s_waitcnt lgkmcnt(4)
  v_mfma_f32_32x32x16_bf16 v[128:143], v[208:211], a[64:67], v[128:143]
  global_load_lds_dwordx4 v240, s[40:41] offset:0
  s_waitcnt vmcnt(47)
  v_mfma_f32_32x32x16_bf16 v[176:191], v[220:223], a[76:79], v[176:191]
  ds_read_b64_tr_b16 v[208:209], v26 offset:26624
  ds_read_b64_tr_b16 v[210:211], v26 offset:27648
  global_load_lds_dwordx4 v241, s[40:41] offset:1024
  v_mfma_f32_32x32x16_bf16 v[160:175], v[216:219], a[76:79], v[160:175]
  ds_read_b64_tr_b16 v[212:213], v27 offset:26624
  ds_read_b64_tr_b16 v[214:215], v27 offset:27648
  global_load_lds_dwordx4 v242, s[40:41] offset:2048
  v_mfma_f32_32x32x16_bf16 v[144:159], v[220:223], a[72:75], v[144:159]
  global_load_lds_dwordx4 v243, s[40:41] offset:3072
  v_mfma_f32_32x32x16_bf16 v[128:143], v[216:219], a[72:75], v[128:143]
  s_waitcnt vmcnt(48)
  v_mfma_f32_32x32x16_bf16 v[176:191], v[228:231], a[84:87], v[176:191]
  ds_read_b64_tr_b16 v[216:217], v26 offset:0
  ds_read_b64_tr_b16 v[218:219], v26 offset:1024
  s_add_u32 m0, s47, 24576
  s_add_u32 s40, s40, 28672
  s_addc_u32 s41, s41, 0
  v_mfma_f32_32x32x16_bf16 v[160:175], v[224:227], a[84:87], v[160:175]
  ds_read_b64_tr_b16 v[220:221], v27 offset:0
  ds_read_b64_tr_b16 v[222:223], v27 offset:1024
  s_waitcnt lgkmcnt(4)
  v_mfma_f32_32x32x16_bf16 v[144:159], v[228:231], a[80:83], v[144:159]
  global_load_lds_dwordx4 v240, s[40:41] offset:0
  v_mfma_f32_32x32x16_bf16 v[128:143], v[224:227], a[80:83], v[128:143]
  global_load_lds_dwordx4 v241, s[40:41] offset:1024
  s_waitcnt vmcnt(48)
  v_mfma_f32_32x32x16_bf16 v[176:191], v[196:199], a[92:95], v[176:191]
  ds_read_b64_tr_b16 v[224:225], v26 offset:2048
  ds_read_b64_tr_b16 v[226:227], v26 offset:3072
  global_load_lds_dwordx4 v242, s[40:41] offset:2048
  v_mfma_f32_32x32x16_bf16 v[160:175], v[192:195], a[92:95], v[160:175]
  ds_read_b64_tr_b16 v[228:229], v27 offset:2048
  ds_read_b64_tr_b16 v[230:231], v27 offset:3072
  global_load_lds_dwordx4 v243, s[40:41] offset:3072
  v_mfma_f32_32x32x16_bf16 v[144:159], v[196:199], a[88:91], v[144:159]
  v_mfma_f32_32x32x16_bf16 v[128:143], v[192:195], a[88:91], v[128:143]
  s_waitcnt vmcnt(48)
  v_mfma_f32_32x32x16_bf16 v[176:191], v[204:207], a[100:103], v[176:191]
  ds_read_b64_tr_b16 v[192:193], v26 offset:4096
  ds_read_b64_tr_b16 v[194:195], v26 offset:5120
  s_add_u32 m0, s47, 0
  s_add_u32 s54, s62, 0
  v_mfma_f32_32x32x16_bf16 v[160:175], v[200:203], a[100:103], v[160:175]
  ds_read_b64_tr_b16 v[196:197], v27 offset:4096
  ds_read_b64_tr_b16 v[198:199], v27 offset:5120
  s_waitcnt lgkmcnt(4)
  v_mfma_f32_32x32x16_bf16 v[144:159], v[204:207], a[96:99], v[144:159]
  buffer_load_dwordx4 v240, s[24:27], s54 offen offset:0 lds
  v_mfma_f32_32x32x16_bf16 v[128:143], v[200:203], a[96:99], v[128:143]
  buffer_load_dwordx4 v241, s[24:27], s54 offen offset:1024 lds
  s_waitcnt vmcnt(48)
  v_mfma_f32_32x32x16_bf16 v[176:191], v[212:215], a[108:111], v[176:191]
  ds_read_b64_tr_b16 v[200:201], v26 offset:6144
  ds_read_b64_tr_b16 v[202:203], v26 offset:7168
  buffer_load_dwordx4 v242, s[24:27], s54 offen offset:2048 lds
  v_mfma_f32_32x32x16_bf16 v[160:175], v[208:211], a[108:111], v[160:175]
  ds_read_b64_tr_b16 v[204:205], v27 offset:6144
  ds_read_b64_tr_b16 v[206:207], v27 offset:7168
  buffer_load_dwordx4 v243, s[24:27], s54 offen offset:3072 lds
  v_mfma_f32_32x32x16_bf16 v[144:159], v[212:215], a[104:107], v[144:159]
  v_mfma_f32_32x32x16_bf16 v[128:143], v[208:211], a[104:107], v[128:143]
  s_waitcnt vmcnt(48)
  v_mfma_f32_32x32x16_bf16 v[176:191], v[220:223], a[116:119], v[176:191]
  ds_read_b64_tr_b16 v[208:209], v26 offset:8192
  ds_read_b64_tr_b16 v[210:211], v26 offset:9216
  s_add_u32 m0, s47, 4096
  s_add_u32 s54, s62, 25088
  v_mfma_f32_32x32x16_bf16 v[160:175], v[216:219], a[116:119], v[160:175]
  ds_read_b64_tr_b16 v[212:213], v27 offset:8192
  ds_read_b64_tr_b16 v[214:215], v27 offset:9216
  s_waitcnt lgkmcnt(4)
  v_mfma_f32_32x32x16_bf16 v[144:159], v[220:223], a[112:115], v[144:159]
  buffer_load_dwordx4 v240, s[24:27], s54 offen offset:0 lds
  v_mfma_f32_32x32x16_bf16 v[128:143], v[216:219], a[112:115], v[128:143]
  buffer_load_dwordx4 v241, s[24:27], s54 offen offset:1024 lds
  s_waitcnt vmcnt(48)
  v_mfma_f32_32x32x16_bf16 v[176:191], v[228:231], a[124:127], v[176:191]
  ds_read_b64_tr_b16 v[216:217], v26 offset:10240
  ds_read_b64_tr_b16 v[218:219], v26 offset:11264
  buffer_load_dwordx4 v242, s[24:27], s54 offen offset:2048 lds
  v_mfma_f32_32x32x16_bf16 v[160:175], v[224:227], a[124:127], v[160:175]
  ds_read_b64_tr_b16 v[220:221], v27 offset:10240
  ds_read_b64_tr_b16 v[222:223], v27 offset:11264
  buffer_load_dwordx4 v243, s[24:27], s54 offen offset:3072 lds
  v_mfma_f32_32x32x16_bf16 v[144:159], v[228:231], a[120:123], v[144:159]
  v_mfma_f32_32x32x16_bf16 v[128:143], v[224:227], a[120:123], v[128:143]
  s_waitcnt vmcnt(48)
  v_mfma_f32_32x32x16_bf16 v[176:191], v[196:199], a[132:135], v[176:191]
  s_waitcnt vmcnt(24)
  ds_read_b64_tr_b16 v[224:225], v26 offset:12288
  ds_read_b64_tr_b16 v[226:227], v26 offset:13312
  s_add_u32 m0, s47, 8192
  s_add_u32 s54, s62, 50176
  v_mfma_f32_32x32x16_bf16 v[160:175], v[192:195], a[132:135], v[160:175]
  ds_read_b64_tr_b16 v[228:229], v27 offset:12288
  ds_read_b64_tr_b16 v[230:231], v27 offset:13312
  s_waitcnt lgkmcnt(4)
  v_mfma_f32_32x32x16_bf16 v[144:159], v[196:199], a[128:131], v[144:159]
  buffer_load_dwordx4 v240, s[24:27], s54 offen offset:0 lds
  v_mfma_f32_32x32x16_bf16 v[128:143], v[192:195], a[128:131], v[128:143]
  buffer_load_dwordx4 v241, s[24:27], s54 offen offset:1024 lds
  v_mfma_f32_32x32x16_bf16 v[176:191], v[204:207], a[140:143], v[176:191]
  s_waitcnt vmcnt(24)
  ds_read_b64_tr_b16 v[192:193], v26 offset:14336
  ds_read_b64_tr_b16 v[194:195], v26 offset:15360
  buffer_load_dwordx4 v242, s[24:27], s54 offen offset:2048 lds
  v_mfma_f32_32x32x16_bf16 v[160:175], v[200:203], a[140:143], v[160:175]
  ds_read_b64_tr_b16 v[196:197], v27 offset:14336
  ds_read_b64_tr_b16 v[198:199], v27 offset:15360
  buffer_load_dwordx4 v243, s[24:27], s54 offen offset:3072 lds
  v_mfma_f32_32x32x16_bf16 v[144:159], v[204:207], a[136:139], v[144:159]
  v_mfma_f32_32x32x16_bf16 v[128:143], v[200:203], a[136:139], v[128:143]
  v_mfma_f32_32x32x16_bf16 v[176:191], v[212:215], a[148:151], v[176:191]
  s_waitcnt vmcnt(24)
  ds_read_b64_tr_b16 v[200:201], v26 offset:16384
  ds_read_b64_tr_b16 v[202:203], v26 offset:17408
  s_add_u32 m0, s47, 12288
  s_add_u32 s54, s62, 75264
  v_mfma_f32_32x32x16_bf16 v[160:175], v[208:211], a[148:151], v[160:175]
  ds_read_b64_tr_b16 v[204:205], v27 offset:16384
  ds_read_b64_tr_b16 v[206:207], v27 offset:17408
  s_waitcnt lgkmcnt(4)
  v_mfma_f32_32x32x16_bf16 v[144:159], v[212:215], a[144:147], v[144:159]
  buffer_load_dwordx4 v240, s[24:27], s54 offen offset:0 lds
  v_mfma_f32_32x32x16_bf16 v[128:143], v[208:211], a[144:147], v[128:143]
  buffer_load_dwordx4 v241, s[24:27], s54 offen offset:1024 lds
  v_mfma_f32_32x32x16_bf16 v[176:191], v[220:223], a[156:159], v[176:191]
  s_waitcnt vmcnt(24)
  ds_read_b64_tr_b16 v[208:209], v26 offset:18432
  ds_read_b64_tr_b16 v[210:211], v26 offset:19456
  buffer_load_dwordx4 v242, s[24:27], s54 offen offset:2048 lds
  v_mfma_f32_32x32x16_bf16 v[160:175], v[216:219], a[156:159], v[160:175]
  ds_read_b64_tr_b16 v[212:213], v27 offset:18432
  ds_read_b64_tr_b16 v[214:215], v27 offset:19456
  buffer_load_dwordx4 v243, s[24:27], s54 offen offset:3072 lds
  v_mfma_f32_32x32x16_bf16 v[144:159], v[220:223], a[152:155], v[144:159]
  v_mfma_f32_32x32x16_bf16 v[128:143], v[216:219], a[152:155], v[128:143]
  v_mfma_f32_32x32x16_bf16 v[176:191], v[228:231], a[164:167], v[176:191]
  s_waitcnt vmcnt(22)
  ds_read_b64_tr_b16 v[216:217], v26 offset:20480
  ds_read_b64_tr_b16 v[218:219], v26 offset:21504
  v_mfma_f32_32x32x16_bf16 v[160:175], v[224:227], a[164:167], v[160:175]
  ds_read_b64_tr_b16 v[220:221], v27 offset:20480
  ds_read_b64_tr_b16 v[222:223], v27 offset:21504
  v_mfma_f32_32x32x16_bf16 v[144:159], v[228:231], a[160:163], v[144:159]
  v_mfma_f32_32x32x16_bf16 v[128:143], v[224:227], a[160:163], v[128:143]
  v_mfma_f32_32x32x16_bf16 v[176:191], v[196:199], a[172:175], v[176:191]
  s_waitcnt vmcnt(20)
  ds_read_b64_tr_b16 v[224:225], v26 offset:22528
  ds_read_b64_tr_b16 v[226:227], v26 offset:23552
  v_mfma_f32_32x32x16_bf16 v[160:175], v[192:195], a[172:175], v[160:175]
  ds_read_b64_tr_b16 v[228:229], v27 offset:22528
  ds_read_b64_tr_b16 v[230:231], v27 offset:23552
  v_mfma_f32_32x32x16_bf16 v[144:159], v[196:199], a[168:171], v[144:159]
  v_mfma_f32_32x32x16_bf16 v[128:143], v[192:195], a[168:171], v[128:143]
  s_waitcnt lgkmcnt(12)
  v_mfma_f32_32x32x16_bf16 v[176:191], v[204:207], a[180:183], v[176:191]
  s_waitcnt vmcnt(18)
  ds_read_b64_tr_b16 v[192:193], v26 offset:24576
  ds_read_b64_tr_b16 v[194:195], v26 offset:25600
  v_mfma_f32_32x32x16_bf16 v[160:175], v[200:203], a[180:183], v[160:175]
  ds_read_b64_tr_b16 v[196:197], v27 offset:24576
  ds_read_b64_tr_b16 v[198:199], v27 offset:25600
  v_mfma_f32_32x32x16_bf16 v[144:159], v[204:207], a[176:179], v[144:159]
  v_mfma_f32_32x32x16_bf16 v[128:143], v[200:203], a[176:179], v[128:143]
  s_waitcnt lgkmcnt(12)
  v_mfma_f32_32x32x16_bf16 v[176:191], v[212:215], a[188:191], v[176:191]
  s_waitcnt vmcnt(16)
  ds_read_b64_tr_b16 v[200:201], v26 offset:26624
  ds_read_b64_tr_b16 v[202:203], v26 offset:27648
  s_add_u32 s38, s98, s63
  s_addc_u32 s39, s99, 0
  global_load_dwordx4 v[68:71], v247, s[38:39] offset:-4096 sc1
  v_mfma_f32_32x32x16_bf16 v[160:175], v[208:211], a[188:191], v[160:175]
  ds_read_b64_tr_b16 v[204:205], v27 offset:26624
  ds_read_b64_tr_b16 v[206:207], v27 offset:27648
  global_load_dwordx4 v[76:79], v247, s[38:39] offset:-3072 sc1
  v_mfma_f32_32x32x16_bf16 v[144:159], v[212:215], a[184:187], v[144:159]
  s_waitcnt vmcnt(16)
  ds_read_b64_tr_b16 a[0:1], v26 offset:0
  ds_read_b64_tr_b16 a[2:3], v26 offset:1024
  global_load_dwordx4 v[84:87], v247, s[38:39] offset:-2048 sc1
  v_mfma_f32_32x32x16_bf16 v[128:143], v[208:211], a[184:187], v[128:143]
  ds_read_b64_tr_b16 a[4:5], v27 offset:0
  ds_read_b64_tr_b16 a[6:7], v27 offset:1024
  global_load_dwordx4 v[92:95], v247, s[38:39] offset:-1024 sc1
  s_waitcnt lgkmcnt(15)
  v_mfma_f32_32x32x16_bf16 v[176:191], v[220:223], a[196:199], v[176:191]
  s_waitcnt vmcnt(16)
  ds_read_b64_tr_b16 a[8:9], v26 offset:2048
  ds_read_b64_tr_b16 a[10:11], v26 offset:3072
  global_load_dwordx4 v[100:103], v247, s[38:39] offset:0 sc1
  v_mfma_f32_32x32x16_bf16 v[160:175], v[216:219], a[196:199], v[160:175]
  ds_read_b64_tr_b16 a[12:13], v27 offset:2048
  ds_read_b64_tr_b16 a[14:15], v27 offset:3072
  global_load_dwordx4 v[108:111], v247, s[38:39] offset:1024 sc1
  v_mfma_f32_32x32x16_bf16 v[144:159], v[220:223], a[192:195], v[144:159]
  s_waitcnt vmcnt(16)
  ds_read_b64_tr_b16 a[16:17], v26 offset:4096
  ds_read_b64_tr_b16 a[18:19], v26 offset:5120
  global_load_dwordx4 v[116:119], v247, s[38:39] offset:2048 sc1
  v_mfma_f32_32x32x16_bf16 v[128:143], v[216:219], a[192:195], v[128:143]
  ds_read_b64_tr_b16 a[20:21], v27 offset:4096
  ds_read_b64_tr_b16 a[22:23], v27 offset:5120
  global_load_dwordx4 v[124:127], v247, s[38:39] offset:3072 sc1
  s_waitcnt lgkmcnt(15)
  v_mfma_f32_32x32x16_bf16 v[176:191], v[228:231], a[204:207], v[176:191]
  s_waitcnt vmcnt(16)
  ds_read_b64_tr_b16 a[24:25], v26 offset:6144
  ds_read_b64_tr_b16 a[26:27], v26 offset:7168
  global_load_dwordx4 v[64:67], v246, s[38:39] offset:-4096 sc1
  v_mfma_f32_32x32x16_bf16 v[160:175], v[224:227], a[204:207], v[160:175]
  ds_read_b64_tr_b16 a[28:29], v27 offset:6144
  ds_read_b64_tr_b16 a[30:31], v27 offset:7168
  global_load_dwordx4 v[72:75], v246, s[38:39] offset:-3072 sc1
  v_mfma_f32_32x32x16_bf16 v[144:159], v[228:231], a[200:203], v[144:159]
  s_waitcnt vmcnt(16)
  ds_read_b64_tr_b16 a[32:33], v26 offset:8192
  ds_read_b64_tr_b16 a[34:35], v26 offset:9216
  global_load_dwordx4 v[80:83], v246, s[38:39] offset:-2048 sc1
  v_mfma_f32_32x32x16_bf16 v[128:143], v[224:227], a[200:203], v[128:143]
  ds_read_b64_tr_b16 a[36:37], v27 offset:8192
  ds_read_b64_tr_b16 a[38:39], v27 offset:9216
  global_load_dwordx4 v[88:91], v246, s[38:39] offset:-1024 sc1
  v_mfma_f32_32x32x16_bf16 v[176:191], v[196:199], a[212:215], v[176:191]
  s_waitcnt vmcnt(16)
  ds_read_b64_tr_b16 a[40:41], v26 offset:10240
  ds_read_b64_tr_b16 a[42:43], v26 offset:11264
  global_load_dwordx4 v[96:99], v246, s[38:39] offset:0 sc1
  v_mfma_f32_32x32x16_bf16 v[160:175], v[192:195], a[212:215], v[160:175]
  ds_read_b64_tr_b16 a[44:45], v27 offset:10240
  ds_read_b64_tr_b16 a[46:47], v27 offset:11264
  global_load_dwordx4 v[104:107], v246, s[38:39] offset:1024 sc1
  v_mfma_f32_32x32x16_bf16 v[144:159], v[196:199], a[208:211], v[144:159]
  s_waitcnt vmcnt(16)
  ds_read_b64_tr_b16 a[48:49], v26 offset:12288
  ds_read_b64_tr_b16 a[50:51], v26 offset:13312
  global_load_dwordx4 v[112:115], v246, s[38:39] offset:2048 sc1
  v_mfma_f32_32x32x16_bf16 v[128:143], v[192:195], a[208:211], v[128:143]
  ds_read_b64_tr_b16 a[52:53], v27 offset:12288
  ds_read_b64_tr_b16 a[54:55], v27 offset:13312
  global_load_dwordx4 v[120:123], v246, s[38:39] offset:3072 sc1
  s_waitcnt lgkmcnt(15)
  v_mfma_f32_32x32x16_bf16 v[176:191], v[204:207], a[220:223], v[176:191]
  s_waitcnt vmcnt(16)
  ds_read_b64_tr_b16 a[56:57], v26 offset:14336
  ds_read_b64_tr_b16 a[58:59], v26 offset:15360
  v_mfma_f32_32x32x16_bf16 v[160:175], v[200:203], a[220:223], v[160:175]
  ds_read_b64_tr_b16 a[60:61], v27 offset:14336
  ds_read_b64_tr_b16 a[62:63], v27 offset:15360
  v_mfma_f32_32x32x16_bf16 v[144:159], v[204:207], a[216:219], v[144:159]
  v_mfma_f32_32x32x16_bf16 v[128:143], v[200:203], a[216:219], v[128:143]
  v_sub_f32 v30, 1.0, v30
  v_sub_f32 v31, 1.0, v31
  s_xor_b32 s52, s46, 1
  s_mul_i32 s52, s52, 28672
  v_add_u32 v4, s52, v2
  s_xor_b32 s52, s46, 2
  s_mul_i32 s52, s52, 28672
  v_add_u32 v5, s52, v2
  s_xor_b32 s52, s46, 3
  s_mul_i32 s52, s52, 28672
  v_add_u32 v6, s52, v2
  v_add_u32 v3, s47, v2
  s_mov_b32 s69, 0
  v_pk_mul_f32 v[176:177], v[176:177], v[30:31] op_sel:[0,1] op_sel_hi:[1,1]
  v_pk_mul_f32 v[178:179], v[178:179], v[30:31] op_sel:[0,1] op_sel_hi:[1,1]
  v_pk_mul_f32 v[180:181], v[180:181], v[30:31] op_sel:[0,1] op_sel_hi:[1,1]
  v_pk_mul_f32 v[182:183], v[182:183], v[30:31] op_sel:[0,1] op_sel_hi:[1,1]
  v_pk_mul_f32 v[184:185], v[184:185], v[30:31] op_sel:[0,1] op_sel_hi:[1,1]
  v_pk_mul_f32 v[186:187], v[186:187], v[30:31] op_sel:[0,1] op_sel_hi:[1,1]
  v_pk_mul_f32 v[188:189], v[188:189], v[30:31] op_sel:[0,1] op_sel_hi:[1,1]
  v_pk_mul_f32 v[190:191], v[190:191], v[30:31] op_sel:[0,1] op_sel_hi:[1,1]
  s_waitcnt vmcnt(8)
  v_max3_u32 v11, v68, v69, v70
  v_max3_u32 v12, v71, v76, v77
  v_max3_u32 v12, v12, v78, v79
  v_max3_u32 v11, v11, v84, v85
  v_max3_u32 v12, v12, v86, v87
  v_max3_u32 v11, v11, v92, v93
  v_max3_u32 v12, v12, v94, v95
  v_max3_u32 v11, v11, v100, v101
  v_max3_u32 v12, v12, v102, v103
  v_max3_u32 v11, v11, v108, v109
  v_max3_u32 v12, v12, v110, v111
  v_max3_u32 v11, v11, v116, v117
  v_max3_u32 v12, v12, v118, v119
  v_max3_u32 v11, v11, v124, v125
  v_max3_u32 v12, v12, v126, v127
  v_max_u32 v11, v11, v12
  v_cmp_eq_u32 vcc, -1, v11
  s_waitcnt lgkmcnt(0)
  s_cbranch_vccnz L_oretry1
L_ook1:
  v_mfma_f32_32x32x16_bf16 v[176:191], a[4:7], v[68:71], v[176:191]
  v_mul_f32 v160, v31, v160
  v_mul_f32 v161, v31, v161
  v_mul_f32 v162, v31, v162
  v_mul_f32 v163, v31, v163
  v_mfma_f32_32x32x16_bf16 v[176:191], a[12:15], v[76:79], v[176:191]
  v_mul_f32 v164, v31, v164
  v_mul_f32 v165, v31, v165
  v_mul_f32 v166, v31, v166
  v_mul_f32 v167, v31, v167
  v_mfma_f32_32x32x16_bf16 v[176:191], a[20:23], v[84:87], v[176:191]
  v_mul_f32 v168, v31, v168
  v_mul_f32 v169, v31, v169
  v_mul_f32 v170, v31, v170
  v_mul_f32 v171, v31, v171
  v_mfma_f32_32x32x16_bf16 v[176:191], a[28:31], v[92:95], v[176:191]
  v_mul_f32 v172, v31, v172
  v_mul_f32 v173, v31, v173
  v_mul_f32 v174, v31, v174
  v_mul_f32 v175, v31, v175
  v_mfma_f32_32x32x16_bf16 v[176:191], a[36:39], v[100:103], v[176:191]
  v_and_b32 v8, 31, v1
  v_mul_u32_u24 v8, 80, v8
  v_lshrrev_b32 v9, 5, v1
  v_mfma_f32_32x32x16_bf16 v[176:191], a[44:47], v[108:111], v[176:191]
  v_lshl_add_u32 v8, v9, 3, v8
  v_add_u32 v8, s47, v8
  v_lshrrev_b32 v9, 2, v1
  v_mfma_f32_32x32x16_bf16 v[176:191], a[52:55], v[116:119], v[176:191]
  v_and_b32 v10, 48, v2
  v_mul_u32_u24 v7, 896, v9
  v_mul_u32_u24 v9, 80, v9
  v_mfma_f32_32x32x16_bf16 v[176:191], a[60:63], v[124:127], v[176:191]
  v_add_u32 v7, v7, v10
  v_add3_u32 v9, v9, v10, s47
  s_lshl_b32 s52, s44, 2
  v_mfma_f32_32x32x16_bf16 v[160:175], a[0:3], v[68:71], v[160:175]
  v_mul_f32 v144, v30, v144
  v_mul_f32 v145, v30, v145
  v_mul_f32 v146, v30, v146
  v_mul_f32 v147, v30, v147
  v_mfma_f32_32x32x16_bf16 v[160:175], a[8:11], v[76:79], v[160:175]
  v_mul_f32 v148, v30, v148
  v_mul_f32 v149, v30, v149
  v_mul_f32 v150, v30, v150
  v_mul_f32 v151, v30, v151
  v_mfma_f32_32x32x16_bf16 v[160:175], a[16:19], v[84:87], v[160:175]
  v_mul_f32 v152, v30, v152
  v_mul_f32 v153, v30, v153
  v_mul_f32 v154, v30, v154
  v_mul_f32 v155, v30, v155
  v_mfma_f32_32x32x16_bf16 v[160:175], a[24:27], v[92:95], v[160:175]
  ds_write_b128 v3, v[176:179] offset:8192
  v_mul_f32 v156, v30, v156
  v_mul_f32 v157, v30, v157
  v_mul_f32 v158, v30, v158
  v_mul_f32 v159, v30, v159
  v_mfma_f32_32x32x16_bf16 v[160:175], a[32:35], v[100:103], v[160:175]
  ds_write_b128 v3, v[180:183] offset:9216
  s_waitcnt vmcnt(0)
  v_max3_u32 v11, v64, v65, v66
  v_max3_u32 v12, v67, v72, v73
  v_max3_u32 v12, v12, v74, v75
  v_max3_u32 v11, v11, v80, v81
  v_mfma_f32_32x32x16_bf16 v[160:175], a[40:43], v[108:111], v[160:175]
  ds_write_b128 v3, v[184:187] offset:10240
  v_max3_u32 v12, v12, v82, v83
  v_max3_u32 v11, v11, v88, v89
  v_max3_u32 v12, v12, v90, v91
  v_max3_u32 v11, v11, v96, v97
  v_mfma_f32_32x32x16_bf16 v[160:175], a[48:51], v[116:119], v[160:175]
  ds_write_b128 v3, v[188:191] offset:11264
  v_max3_u32 v12, v12, v98, v99
  v_max3_u32 v11, v11, v104, v105
  v_max3_u32 v12, v12, v106, v107
  v_max3_u32 v11, v11, v112, v113
  v_mfma_f32_32x32x16_bf16 v[160:175], a[56:59], v[124:127], v[160:175]
  v_max3_u32 v12, v12, v114, v115
  v_max3_u32 v11, v11, v120, v121
  v_max3_u32 v12, v12, v122, v123
  v_max_u32 v11, v11, v12
  v_cmp_eq_u32 vcc, -1, v11
  s_nop 1
  s_cbranch_vccnz L_oretry0
L_ook0:
  v_mfma_f32_32x32x16_bf16 v[144:159], a[4:7], v[64:67], v[144:159]
  v_mul_f32 v128, v30, v128
  v_mul_f32 v129, v30, v129
  v_mul_f32 v130, v30, v130
  v_mul_f32 v131, v30, v131
  v_mfma_f32_32x32x16_bf16 v[144:159], a[12:15], v[72:75], v[144:159]
  v_mul_f32 v132, v30, v132
  v_mul_f32 v133, v30, v133
  v_mul_f32 v134, v30, v134
  v_mul_f32 v135, v30, v135
  v_mfma_f32_32x32x16_bf16 v[144:159], a[20:23], v[80:83], v[144:159]
  v_mul_f32 v136, v30, v136
  v_mul_f32 v137, v30, v137
  v_mul_f32 v138, v30, v138
  v_mul_f32 v139, v30, v139
  v_mfma_f32_32x32x16_bf16 v[144:159], a[28:31], v[88:91], v[144:159]
  ds_write_b128 v3, v[160:163] offset:4096
  v_mul_f32 v140, v30, v140
  v_mul_f32 v141, v30, v141
  v_mul_f32 v142, v30, v142
  v_mul_f32 v143, v30, v143
  v_mfma_f32_32x32x16_bf16 v[144:159], a[36:39], v[96:99], v[144:159]
  ds_write_b128 v3, v[164:167] offset:5120
  s_lshl_b32 s53, s64, 1
  s_add_u32 s52, s52, s53
  s_lshr_b32 s53, s46, 1
  v_mfma_f32_32x32x16_bf16 v[144:159], a[44:47], v[104:107], v[144:159]
  ds_write_b128 v3, v[168:171] offset:6144
  s_add_u32 s52, s52, s53
  s_mul_i32 s52, s52, 28672
  s_lshl_b32 s53, s65, 7
  v_mfma_f32_32x32x16_bf16 v[144:159], a[52:55], v[112:115], v[144:159]
  ds_write_b128 v3, v[172:175] offset:7168
  s_add_u32 s52, s52, s53
  s_and_b32 s53, s46, 1
  s_lshl_b32 s53, s53, 6
  v_mfma_f32_32x32x16_bf16 v[144:159], a[60:63], v[120:123], v[144:159]
  s_add_u32 s52, s52, s53
  s_add_u32 s53, s52, 14336
  v_mfma_f32_32x32x16_bf16 v[128:143], a[0:3], v[64:67], v[128:143]
  s_nop 4
  v_mfma_f32_32x32x16_bf16 v[128:143], a[8:11], v[72:75], v[128:143]
  s_nop 4
  v_mfma_f32_32x32x16_bf16 v[128:143], a[16:19], v[80:83], v[128:143]
  ds_write_b128 v3, v[144:147] offset:0
  ds_write_b128 v3, v[148:151] offset:1024
  v_mfma_f32_32x32x16_bf16 v[128:143], a[24:27], v[88:91], v[128:143]
  ds_write_b128 v3, v[152:155] offset:2048
  ds_write_b128 v3, v[156:159] offset:3072
  v_mfma_f32_32x32x16_bf16 v[128:143], a[32:35], v[96:99], v[128:143]
  v_mfma_f32_32x32x16_bf16 v[128:143], a[40:43], v[104:107], v[128:143]
  s_waitcnt lgkmcnt(0)
  s_barrier
  ds_read_b128 v[192:195], v4 offset:0
  ds_read_b128 v[196:199], v4 offset:1024
  ds_read_b128 v[200:203], v4 offset:2048
  ds_read_b128 v[204:207], v4 offset:3072
  v_mfma_f32_32x32x16_bf16 v[128:143], a[48:51], v[112:115], v[128:143]
  ds_read_b128 v[208:211], v5 offset:4096
  ds_read_b128 v[212:215], v5 offset:5120
  ds_read_b128 v[216:219], v5 offset:6144
  ds_read_b128 v[220:223], v5 offset:7168
  v_mfma_f32_32x32x16_bf16 v[128:143], a[56:59], v[120:123], v[128:143]
  ds_read_b128 v[224:227], v6 offset:8192
  ds_read_b128 v[228:231], v6 offset:9216
  ds_read_b128 v[232:235], v6 offset:10240
  ds_read_b128 v[236:239], v6 offset:11264
  s_waitcnt lgkmcnt(4)
  v_pk_add_f32 v[192:193], v[192:193], v[208:209]
  v_pk_add_f32 v[194:195], v[194:195], v[210:211]
  v_pk_add_f32 v[196:197], v[196:197], v[212:213]
  v_pk_add_f32 v[198:199], v[198:199], v[214:215]
  v_pk_add_f32 v[200:201], v[200:201], v[216:217]
  v_pk_add_f32 v[202:203], v[202:203], v[218:219]
  v_pk_add_f32 v[204:205], v[204:205], v[220:221]
  v_pk_add_f32 v[206:207], v[206:207], v[222:223]
  s_waitcnt lgkmcnt(0)
  s_nop 7
  v_pk_add_f32 v[128:129], v[128:129], v[224:225]
  v_pk_add_f32 v[130:131], v[130:131], v[226:227]
  v_pk_add_f32 v[132:133], v[132:133], v[228:229]
  v_pk_add_f32 v[134:135], v[134:135], v[230:231]
  v_pk_add_f32 v[136:137], v[136:137], v[232:233]
  v_pk_add_f32 v[138:139], v[138:139], v[234:235]
  v_pk_add_f32 v[140:141], v[140:141], v[236:237]
  v_pk_add_f32 v[142:143], v[142:143], v[238:239]
  v_pk_add_f32 v[128:129], v[128:129], v[192:193]
  v_pk_add_f32 v[130:131], v[130:131], v[194:195]
  v_cvt_pk_bf16_f32 v32, v128, v129
  v_cvt_pk_bf16_f32 v33, v130, v131
  ds_write_b64 v8, v[32:33] offset:16384
  v_pk_add_f32 v[132:133], v[132:133], v[196:197]
  v_pk_add_f32 v[134:135], v[134:135], v[198:199]
  v_cvt_pk_bf16_f32 v34, v132, v133
  v_cvt_pk_bf16_f32 v35, v134, v135
  ds_write_b64 v8, v[34:35] offset:16400
  v_pk_add_f32 v[136:137], v[136:137], v[200:201]
  v_pk_add_f32 v[138:139], v[138:139], v[202:203]
  v_cvt_pk_bf16_f32 v36, v136, v137
  v_cvt_pk_bf16_f32 v37, v138, v139
  ds_write_b64 v8, v[36:37] offset:16416
  v_pk_add_f32 v[140:141], v[140:141], v[204:205]
  v_pk_add_f32 v[142:143], v[142:143], v[206:207]
  v_cvt_pk_bf16_f32 v38, v140, v141
  v_cvt_pk_bf16_f32 v39, v142, v143
  ds_write_b64 v8, v[38:39] offset:16432
  ds_read_b128 v[40:43], v9 offset:16384
  ds_read_b128 v[44:47], v9 offset:17664
  s_waitcnt lgkmcnt(1)
  buffer_store_dwordx4 v[40:43], v7, s[28:31], s52 offen sc1
  s_waitcnt lgkmcnt(0)
  buffer_store_dwordx4 v[44:47], v7, s[28:31], s53 offen sc1
L_fin:
  s_endpgm
L_i2:
  s_mov_b32 s93, s47
  s_mov_b32 s16, s100
  s_and_b32 s17, s101, 0xffff
  s_mov_b32 s18, 896
  s_mov_b32 s19, 0x20000
  s_mov_b32 m0, 155648
  s_movk_i32 s69, 896
  buffer_load_dwordx4 v2, s[16:19], 0 offen lds
  s_mov_b32 s3, s49
  s_mul_i32 s53, s3, s48
  s_add_u32 m0, s92, 114688
  s_add_u32 s53, s53, s54
  buffer_load_dwordx4 v16, s[12:15], s53 offen  lds
  s_lshl_b32 s53, s3, 7
  s_add_u32 m0, s93, 0
  s_add_u32 s53, s53, s55
  buffer_load_dwordx4 v8, s[8:11], s53 offen offset:0  lds
  buffer_load_dwordx4 v9, s[8:11], s53 offen offset:1024  lds
  buffer_load_dwordx4 v10, s[8:11], s53 offen offset:2048  lds
  buffer_load_dwordx4 v11, s[8:11], s53 offen offset:3072  lds
  s_add_u32 s3, s3, 1
  s_cmp_eq_u32 s3, 7
  s_cselect_b32 s3, 0, s3
  s_mul_i32 s53, s3, s48
  s_add_u32 m0, s92, 118784
  s_add_u32 s53, s53, s54
  buffer_load_dwordx4 v16, s[12:15], s53 offen  lds
  s_lshl_b32 s53, s3, 7
  s_add_u32 m0, s93, 4096
  s_add_u32 s53, s53, s55
  buffer_load_dwordx4 v8, s[8:11], s53 offen offset:0  lds
  buffer_load_dwordx4 v9, s[8:11], s53 offen offset:1024  lds
  buffer_load_dwordx4 v10, s[8:11], s53 offen offset:2048  lds
  buffer_load_dwordx4 v11, s[8:11], s53 offen offset:3072  lds
  s_add_u32 s3, s3, 1
  s_cmp_eq_u32 s3, 7
  s_cselect_b32 s3, 0, s3
  s_mul_i32 s53, s3, s48
  s_add_u32 m0, s92, 122880
  s_add_u32 s53, s53, s54
  buffer_load_dwordx4 v16, s[12:15], s53 offen  lds
  s_lshl_b32 s53, s3, 7
  s_add_u32 m0, s93, 8192
  s_add_u32 s53, s53, s55
  buffer_load_dwordx4 v8, s[8:11], s53 offen offset:0  lds
  buffer_load_dwordx4 v9, s[8:11], s53 offen offset:1024  lds
  buffer_load_dwordx4 v10, s[8:11], s53 offen offset:2048  lds
  buffer_load_dwordx4 v11, s[8:11], s53 offen offset:3072  lds
  s_mov_b32 s16, s6
  s_and_b32 s17, s7, 0xffff
  s_mov_b32 s18, 401408
  s_mov_b32 s19, 0x20000
  v_mad_u32_u24 v17, v3, s69, v4
  s_mul_i32 s51, s45, 56
  s_mul_i32 s53, s46, 14336
  s_add_u32 s51, s51, s53
  s_branch L_i3
L_z1:
  s_mov_b32 s20, s98
  s_and_b32 s21, s99, 0xffff
  s_mov_b32 s22, 33554432
  s_mov_b32 s23, 0x20000
  s_mul_i32 s53, s44, 0x2200
  s_add_u32 s53, s53, 524288
  v_lshrrev_b32 v161, 5, v0
  v_mul_u32_u24 v161, 4224, v161
  v_lshl_add_u32 v161, v0, 2, v161
  v_mov_b32 v163, 0
  buffer_store_dword v163, v161, s[20:23], s53 offen sc1
  s_branch L_z1r
L_z2:
  s_mov_b32 s32, s96
  s_and_b32 s33, s97, 0xffff
  s_mov_b32 s34, 256
  s_mov_b32 s35, 0x20000
  v_mov_b32 v248, 1
  s_waitcnt vmcnt(9)
  v_lshlrev_b32 v164, 7, v0
  buffer_atomic_add v248, v164, s[32:35], 0 offen sc1
  s_branch L_z2r
L_sp0b:
  s_mov_b32 s69, 0
  s_cmp_lg_u32 s46, 0
  s_cbranch_scc1 L_ok0b
L_sq0b:
  s_sleep 8
  buffer_load_dword v28, v162, s[32:35], 0 offen offset:128 sc1
  s_add_u32 s69, s69, 1
  s_waitcnt vmcnt(0)
  s_cmp_ge_u32 s69, 0x40000
  s_cbranch_scc1 L_ok0b
  v_readfirstlane_b32 s52, v28
  s_cmp_ge_u32 s52, 16
  s_cbranch_scc0 L_sq0b
  s_branch L_ok0b
L_sp1b:
  s_mov_b32 s69, 0

L_sq1b:
  s_sleep 8
  buffer_load_dword v28, v160, s[20:23], 0 offen sc1
  s_add_u32 s69, s69, 1
  s_waitcnt vmcnt(0)
  s_cmp_ge_u32 s69, 0x40000
  s_cbranch_scc1 L_ok1b
  v_cmp_eq_u32 vcc, 1, v28
  s_cmp_eq_u64 vcc, -1
  s_cbranch_scc0 L_sq1b
  s_branch L_ok1b
L_sp:
  s_cmp_eq_u32 s45, 8
  s_cbranch_scc1 L_av
L_ak:
  s_lshl1_add_u32 s53, s44, s64
  s_lshl2_add_u32 s53, s53, 524288
  v_mul_u32_u24 v161, 0x1100, v0
  v_add_u32 v161, s53, v161
  v_mov_b32 v163, 33554432
  v_cmp_gt_u32 vcc, 32, v0
  s_nop 0
  v_cndmask_b32 v161, v163, v161, vcc
  v_lshrrev_b32 v5, 5, v1
  v_lshlrev_b32 v5, 4, v5
  v_add_u32 v5, 155648, v5
  s_mov_b32 s50, s49
  s_lshl_b32 s69, s50, 7
  v_add_u32 v7, s69, v5
  s_add_u32 s50, s50, 1
  s_cmp_eq_u32 s50, 7
  s_cselect_b32 s50, 0, s50
  s_waitcnt vmcnt(11)
  ds_read_b128 a[0:3], v12 offset:0
  ds_read_b128 a[4:7], v13 offset:0
  ds_read_b128 a[8:11], v14 offset:0
  ds_read_b128 a[12:15], v15 offset:0
  s_barrier
  ds_read_b64_tr_b16 v[32:33], v21 offset:0
  ds_read_b64_tr_b16 v[34:35], v21 offset:256
  ds_read_b64_tr_b16 v[36:37], v21 offset:1024
  ds_read_b64_tr_b16 v[38:39], v21 offset:1280
  ds_read_b64_tr_b16 v[40:41], v21 offset:2048
  ds_read_b64_tr_b16 v[42:43], v21 offset:2304
  ds_read_b64_tr_b16 v[44:45], v21 offset:3072
  ds_read_b64_tr_b16 v[46:47], v21 offset:3328
  ds_read_b128 v[96:99], v7 offset:0
  ds_read_b128 v[100:103], v7 offset:32
  ds_read_b128 v[104:107], v7 offset:64
  ds_read_b128 v[108:111], v7 offset:96
  s_add_u32 s3, s3, 1
  s_cmp_eq_u32 s3, 7
  s_cselect_b32 s3, 0, s3
  s_mul_i32 s53, s3, s48
  s_add_u32 m0, s92, 126976
  s_add_u32 s53, s53, s54
  buffer_load_dwordx4 v16, s[12:15], s53 offen  lds
  s_lshl_b32 s53, s3, 7
  s_add_u32 m0, s93, 12288
  s_add_u32 s53, s53, s55
  buffer_load_dwordx4 v8, s[8:11], s53 offen offset:0  lds
  buffer_load_dwordx4 v9, s[8:11], s53 offen offset:1024  lds
  buffer_load_dwordx4 v10, s[8:11], s53 offen offset:2048  lds
  buffer_load_dwordx4 v11, s[8:11], s53 offen offset:3072  lds
  s_lshl_b32 s69, s50, 7
  v_add_u32 v7, s69, v5
  s_add_u32 s50, s50, 1
  s_cmp_eq_u32 s50, 7
  s_cselect_b32 s50, 0, s50
  s_waitcnt vmcnt(11)
  s_waitcnt lgkmcnt(0)
  ds_read_b128 a[16:19], v12 offset:4096
  ds_read_b128 a[20:23], v13 offset:4096
  ds_read_b128 a[24:27], v14 offset:4096
  ds_read_b128 a[28:31], v15 offset:4096
  s_barrier
  ds_read_b64_tr_b16 v[48:49], v21 offset:4096
  ds_read_b64_tr_b16 v[50:51], v21 offset:4352
  ds_read_b64_tr_b16 v[52:53], v21 offset:5120
  ds_read_b64_tr_b16 v[54:55], v21 offset:5376
  ds_read_b64_tr_b16 v[56:57], v21 offset:6144
  ds_read_b64_tr_b16 v[58:59], v21 offset:6400
  ds_read_b64_tr_b16 v[60:61], v21 offset:7168
  ds_read_b64_tr_b16 v[62:63], v21 offset:7424
  v_mfma_f32_32x32x16_bf16 v[64:79], v[32:35], a[0:3], 0
  ds_read_b128 v[112:115], v7 offset:0
  ds_read_b128 v[116:119], v7 offset:32
  v_mfma_f32_32x32x16_bf16 v[80:95], v[96:99], a[0:3], 0
  ds_read_b128 v[120:123], v7 offset:64
  v_mfma_f32_32x32x16_bf16 v[64:79], v[36:39], a[4:7], v[64:79]
  ds_read_b128 v[124:127], v7 offset:96
  s_add_u32 s3, s3, 1
  s_cmp_eq_u32 s3, 7
  s_cselect_b32 s3, 0, s3
  v_mfma_f32_32x32x16_bf16 v[80:95], v[100:103], a[4:7], v[80:95]
  s_mul_i32 s53, s3, s48
  s_add_u32 m0, s92, 131072
  s_add_u32 s53, s53, s54
  v_mfma_f32_32x32x16_bf16 v[64:79], v[40:43], a[8:11], v[64:79]
  buffer_load_dwordx4 v16, s[12:15], s53 offen  lds
  s_lshl_b32 s53, s3, 7
  s_add_u32 m0, s93, 16384
  s_add_u32 s53, s53, s55
  v_mfma_f32_32x32x16_bf16 v[80:95], v[104:107], a[8:11], v[80:95]
  buffer_load_dwordx4 v8, s[8:11], s53 offen offset:0  lds
  v_mfma_f32_32x32x16_bf16 v[64:79], v[44:47], a[12:15], v[64:79]
  buffer_load_dwordx4 v9, s[8:11], s53 offen offset:1024  lds
  buffer_load_dwordx4 v10, s[8:11], s53 offen offset:2048  lds
  v_mfma_f32_32x32x16_bf16 v[80:95], v[108:111], a[12:15], v[80:95]
  buffer_load_dwordx4 v11, s[8:11], s53 offen offset:3072  lds
  s_lshl_b32 s69, s50, 7
  v_add_u32 v7, s69, v5
  s_add_u32 s50, s50, 1
  s_cmp_eq_u32 s50, 7
  s_cselect_b32 s50, 0, s50
  s_waitcnt vmcnt(11)
  s_waitcnt lgkmcnt(0)
  ds_read_b128 a[32:35], v12 offset:8192
  ds_read_b128 a[36:39], v13 offset:8192
  ds_read_b128 a[40:43], v14 offset:8192
  ds_read_b128 a[44:47], v15 offset:8192
  s_barrier
  ds_read_b64_tr_b16 v[32:33], v21 offset:8192
  ds_read_b64_tr_b16 v[34:35], v21 offset:8448
  ds_read_b64_tr_b16 v[36:37], v21 offset:9216
  ds_read_b64_tr_b16 v[38:39], v21 offset:9472
  ds_read_b64_tr_b16 v[40:41], v21 offset:10240
  ds_read_b64_tr_b16 v[42:43], v21 offset:10496
  ds_read_b64_tr_b16 v[44:45], v21 offset:11264
  ds_read_b64_tr_b16 v[46:47], v21 offset:11520
  v_mfma_f32_32x32x16_bf16 v[64:79], v[48:51], a[16:19], v[64:79]
  ds_read_b128 v[96:99], v7 offset:0
  ds_read_b128 v[100:103], v7 offset:32
  v_mfma_f32_32x32x16_bf16 v[80:95], v[112:115], a[16:19], v[80:95]
  ds_read_b128 v[104:107], v7 offset:64
  v_mfma_f32_32x32x16_bf16 v[64:79], v[52:55], a[20:23], v[64:79]
  ds_read_b128 v[108:111], v7 offset:96
  s_add_u32 s3, s3, 1
  s_cmp_eq_u32 s3, 7
  s_cselect_b32 s3, 0, s3
  v_mfma_f32_32x32x16_bf16 v[80:95], v[116:119], a[20:23], v[80:95]
  s_mul_i32 s53, s3, s48
  s_add_u32 m0, s92, 135168
  s_add_u32 s53, s53, s54
  v_mfma_f32_32x32x16_bf16 v[64:79], v[56:59], a[24:27], v[64:79]
  buffer_load_dwordx4 v16, s[12:15], s53 offen  lds
  s_lshl_b32 s53, s3, 7
  s_add_u32 m0, s93, 20480
  s_add_u32 s53, s53, s55
  v_mfma_f32_32x32x16_bf16 v[80:95], v[120:123], a[24:27], v[80:95]
  buffer_load_dwordx4 v8, s[8:11], s53 offen offset:0  lds
  v_mfma_f32_32x32x16_bf16 v[64:79], v[60:63], a[28:31], v[64:79]
  buffer_load_dwordx4 v9, s[8:11], s53 offen offset:1024  lds
  buffer_load_dwordx4 v10, s[8:11], s53 offen offset:2048  lds
  v_mfma_f32_32x32x16_bf16 v[80:95], v[124:127], a[28:31], v[80:95]
  buffer_load_dwordx4 v11, s[8:11], s53 offen offset:3072  lds
  s_lshl_b32 s69, s50, 7
  v_add_u32 v7, s69, v5
  s_add_u32 s50, s50, 1
  s_cmp_eq_u32 s50, 7
  s_cselect_b32 s50, 0, s50
  s_waitcnt vmcnt(10)
  s_waitcnt lgkmcnt(0)
  ds_read_b128 a[48:51], v12 offset:12288
  ds_read_b128 a[52:55], v13 offset:12288
  ds_read_b128 a[56:59], v14 offset:12288
  ds_read_b128 a[60:63], v15 offset:12288
  s_barrier
  ds_read_b64_tr_b16 v[48:49], v21 offset:12288
  ds_read_b64_tr_b16 v[50:51], v21 offset:12544
  ds_read_b64_tr_b16 v[52:53], v21 offset:13312
  ds_read_b64_tr_b16 v[54:55], v21 offset:13568
  ds_read_b64_tr_b16 v[56:57], v21 offset:14336
  ds_read_b64_tr_b16 v[58:59], v21 offset:14592
  ds_read_b64_tr_b16 v[60:61], v21 offset:15360
  ds_read_b64_tr_b16 v[62:63], v21 offset:15616
  v_mfma_f32_32x32x16_bf16 v[64:79], v[32:35], a[32:35], v[64:79]
  ds_read_b128 v[112:115], v7 offset:0
  ds_read_b128 v[116:119], v7 offset:32
  v_mfma_f32_32x32x16_bf16 v[80:95], v[96:99], a[32:35], v[80:95]
  ds_read_b128 v[120:123], v7 offset:64
  v_mfma_f32_32x32x16_bf16 v[64:79], v[36:39], a[36:39], v[64:79]
  ds_read_b128 v[124:127], v7 offset:96
  s_add_u32 s3, s3, 1
  s_cmp_eq_u32 s3, 7
  s_cselect_b32 s3, 0, s3
  v_mfma_f32_32x32x16_bf16 v[80:95], v[100:103], a[36:39], v[80:95]
  s_mul_i32 s53, s3, s48
  s_add_u32 m0, s92, 139264
  s_add_u32 s53, s53, s54
  v_mfma_f32_32x32x16_bf16 v[64:79], v[40:43], a[40:43], v[64:79]
  buffer_load_dwordx4 v16, s[12:15], s53 offen  lds
  s_lshl_b32 s53, s3, 7
  s_add_u32 m0, s93, 24576
  s_add_u32 s53, s53, s55
  v_mfma_f32_32x32x16_bf16 v[80:95], v[104:107], a[40:43], v[80:95]
  buffer_load_dwordx4 v8, s[8:11], s53 offen offset:0  lds
  v_mfma_f32_32x32x16_bf16 v[64:79], v[44:47], a[44:47], v[64:79]
  buffer_load_dwordx4 v9, s[8:11], s53 offen offset:1024  lds
  buffer_load_dwordx4 v10, s[8:11], s53 offen offset:2048  lds
  v_mfma_f32_32x32x16_bf16 v[80:95], v[108:111], a[44:47], v[80:95]
  buffer_load_dwordx4 v11, s[8:11], s53 offen offset:3072  lds
  s_lshl_b32 s69, s50, 7
  v_add_u32 v7, s69, v5
  s_add_u32 s50, s50, 1
  s_cmp_eq_u32 s50, 7
  s_cselect_b32 s50, 0, s50
  s_waitcnt vmcnt(10)
  s_waitcnt lgkmcnt(0)
  ds_read_b128 a[64:67], v12 offset:16384
  ds_read_b128 a[68:71], v13 offset:16384
  ds_read_b128 a[72:75], v14 offset:16384
  ds_read_b128 a[76:79], v15 offset:16384
  s_barrier
  ds_read_b64_tr_b16 v[32:33], v21 offset:16384
  ds_read_b64_tr_b16 v[34:35], v21 offset:16640
  ds_read_b64_tr_b16 v[36:37], v21 offset:17408
  ds_read_b64_tr_b16 v[38:39], v21 offset:17664
  ds_read_b64_tr_b16 v[40:41], v21 offset:18432
  ds_read_b64_tr_b16 v[42:43], v21 offset:18688
  ds_read_b64_tr_b16 v[44:45], v21 offset:19456
  ds_read_b64_tr_b16 v[46:47], v21 offset:19712
  v_mfma_f32_32x32x16_bf16 v[64:79], v[48:51], a[48:51], v[64:79]
  ds_read_b128 v[96:99], v7 offset:0
  ds_read_b128 v[100:103], v7 offset:32
  v_mfma_f32_32x32x16_bf16 v[80:95], v[112:115], a[48:51], v[80:95]
  ds_read_b128 v[104:107], v7 offset:64
  v_mfma_f32_32x32x16_bf16 v[64:79], v[52:55], a[52:55], v[64:79]
  ds_read_b128 v[108:111], v7 offset:96
  s_mov_b32 s3, s49
  v_mfma_f32_32x32x16_bf16 v[80:95], v[116:119], a[52:55], v[80:95]
  s_mul_i32 s53, s3, 57344
  s_add_u32 m0, s47, 0
  s_add_u32 s53, s53, s51
  v_mfma_f32_32x32x16_bf16 v[64:79], v[56:59], a[56:59], v[64:79]
  buffer_load_dwordx4 v17, s[16:19], s53 offen lds
  s_add_u32 s3, s3, 1
  s_cmp_eq_u32 s3, 7
  s_cselect_b32 s3, 0, s3
  v_mfma_f32_32x32x16_bf16 v[80:95], v[120:123], a[56:59], v[80:95]
  s_mul_i32 s53, s3, 57344
  s_add_u32 m0, s47, 1024
  s_add_u32 s53, s53, s51
  v_mfma_f32_32x32x16_bf16 v[64:79], v[60:63], a[60:63], v[64:79]
  buffer_load_dwordx4 v17, s[16:19], s53 offen lds
  s_add_u32 s3, s3, 1
  s_cmp_eq_u32 s3, 7
  s_cselect_b32 s3, 0, s3
  v_mfma_f32_32x32x16_bf16 v[80:95], v[124:127], a[60:63], v[80:95]
  s_mul_i32 s53, s3, 57344
  s_add_u32 m0, s47, 2048
  s_add_u32 s53, s53, s51
  buffer_load_dwordx4 v17, s[16:19], s53 offen lds
  s_add_u32 s3, s3, 1
  s_cmp_eq_u32 s3, 7
  s_cselect_b32 s3, 0, s3
  s_mul_i32 s53, s3, 57344
  s_add_u32 m0, s47, 3072
  s_add_u32 s53, s53, s51
  buffer_load_dwordx4 v17, s[16:19], s53 offen lds
  s_add_u32 s3, s3, 1
  s_cmp_eq_u32 s3, 7
  s_cselect_b32 s3, 0, s3
  s_mul_i32 s53, s3, 57344
  s_add_u32 m0, s47, 4096
  s_add_u32 s53, s53, s51
  buffer_load_dwordx4 v17, s[16:19], s53 offen lds
  s_add_u32 s3, s3, 1
  s_cmp_eq_u32 s3, 7
  s_cselect_b32 s3, 0, s3
  s_mul_i32 s53, s3, 57344
  s_add_u32 m0, s47, 5120
  s_add_u32 s53, s53, s51
  buffer_load_dwordx4 v17, s[16:19], s53 offen lds
  s_add_u32 s3, s3, 1
  s_cmp_eq_u32 s3, 7
  s_cselect_b32 s3, 0, s3
  s_mul_i32 s53, s3, 57344
  s_add_u32 m0, s47, 6144
  s_add_u32 s53, s53, s51
  buffer_load_dwordx4 v17, s[16:19], s53 offen lds
  s_lshl_b32 s69, s50, 7
  v_add_u32 v7, s69, v5
  s_add_u32 s50, s50, 1
  s_cmp_eq_u32 s50, 7
  s_cselect_b32 s50, 0, s50
  s_waitcnt vmcnt(12)
  buffer_load_dword v28, v162, s[32:35], 0 offen offset:128 sc1
  s_waitcnt lgkmcnt(0)
  ds_read_b128 a[80:83], v12 offset:20480
  ds_read_b128 a[84:87], v13 offset:20480
  ds_read_b128 a[88:91], v14 offset:20480
  ds_read_b128 a[92:95], v15 offset:20480
  s_barrier
  ds_read_b64_tr_b16 v[48:49], v21 offset:20480
  ds_read_b64_tr_b16 v[50:51], v21 offset:20736
  ds_read_b64_tr_b16 v[52:53], v21 offset:21504
  ds_read_b64_tr_b16 v[54:55], v21 offset:21760
  ds_read_b64_tr_b16 v[56:57], v21 offset:22528
  ds_read_b64_tr_b16 v[58:59], v21 offset:22784
  ds_read_b64_tr_b16 v[60:61], v21 offset:23552
  ds_read_b64_tr_b16 v[62:63], v21 offset:23808
  v_mfma_f32_32x32x16_bf16 v[64:79], v[32:35], a[64:67], v[64:79]
  ds_read_b128 v[112:115], v7 offset:0
  ds_read_b128 v[116:119], v7 offset:32
  v_mfma_f32_32x32x16_bf16 v[80:95], v[96:99], a[64:67], v[80:95]
  ds_read_b128 v[120:123], v7 offset:64
  v_mfma_f32_32x32x16_bf16 v[64:79], v[36:39], a[68:71], v[64:79]
  ds_read_b128 v[124:127], v7 offset:96
  v_mfma_f32_32x32x16_bf16 v[80:95], v[100:103], a[68:71], v[80:95]
  v_mfma_f32_32x32x16_bf16 v[64:79], v[40:43], a[72:75], v[64:79]
  v_mfma_f32_32x32x16_bf16 v[80:95], v[104:107], a[72:75], v[80:95]
  v_mfma_f32_32x32x16_bf16 v[64:79], v[44:47], a[76:79], v[64:79]
  v_mfma_f32_32x32x16_bf16 v[80:95], v[108:111], a[76:79], v[80:95]
  s_lshl_b32 s69, s50, 7
  v_add_u32 v7, s69, v5
  s_add_u32 s50, s50, 1
  s_cmp_eq_u32 s50, 7
  s_cselect_b32 s50, 0, s50
  s_waitcnt vmcnt(8)
  s_waitcnt lgkmcnt(0)
  ds_read_b128 a[96:99], v12 offset:24576
  ds_read_b128 a[100:103], v13 offset:24576
  ds_read_b128 a[104:107], v14 offset:24576
  ds_read_b128 a[108:111], v15 offset:24576
  s_barrier
  ds_read_b64_tr_b16 v[32:33], v21 offset:24576
  ds_read_b64_tr_b16 v[34:35], v21 offset:24832
  ds_read_b64_tr_b16 v[36:37], v21 offset:25600
  ds_read_b64_tr_b16 v[38:39], v21 offset:25856
  ds_read_b64_tr_b16 v[40:41], v21 offset:26624
  ds_read_b64_tr_b16 v[42:43], v21 offset:26880
  ds_read_b64_tr_b16 v[44:45], v21 offset:27648
  ds_read_b64_tr_b16 v[46:47], v21 offset:27904
  v_mfma_f32_32x32x16_bf16 v[64:79], v[48:51], a[80:83], v[64:79]
  ds_read_b128 v[96:99], v7 offset:0
  ds_read_b128 v[100:103], v7 offset:32
  v_mfma_f32_32x32x16_bf16 v[80:95], v[112:115], a[80:83], v[80:95]
  ds_read_b128 v[104:107], v7 offset:64
  v_mfma_f32_32x32x16_bf16 v[64:79], v[52:55], a[84:87], v[64:79]
  ds_read_b128 v[108:111], v7 offset:96
  v_mfma_f32_32x32x16_bf16 v[80:95], v[116:119], a[84:87], v[80:95]
  v_mfma_f32_32x32x16_bf16 v[64:79], v[56:59], a[88:91], v[64:79]
  v_mfma_f32_32x32x16_bf16 v[80:95], v[120:123], a[88:91], v[80:95]
  v_mfma_f32_32x32x16_bf16 v[64:79], v[60:63], a[92:95], v[64:79]
  v_mfma_f32_32x32x16_bf16 v[80:95], v[124:127], a[92:95], v[80:95]
  s_waitcnt lgkmcnt(0)
  v_mfma_f32_32x32x16_bf16 v[64:79], v[32:35], a[96:99], v[64:79]
  v_mfma_f32_32x32x16_bf16 v[64:79], v[36:39], a[100:103], v[64:79]
  v_mfma_f32_32x32x16_bf16 v[64:79], v[40:43], a[104:107], v[64:79]
  v_mfma_f32_32x32x16_bf16 v[64:79], v[44:47], a[108:111], v[64:79]
  v_lshlrev_b32 v3, 7, v1
  v_cmp_gt_u32 vcc, 1, v1
  v_mov_b32 v5, 33554432
  s_lshl_b32 s52, s56, 12
  v_cndmask_b32 v5, v5, v3, vcc
  buffer_store_dword v250, v5, s[20:23], s58 offen sc1
  v_mov_b32 v3, 0x3f803f80
  v_mov_b32 v4, 0x00003f80
  s_nop 7
  v_cvt_pk_bf16_f32 v48, v64, v65
  v_cvt_pk_bf16_f32 v49, v66, v67
  v_cvt_pk_bf16_f32 v50, v68, v69
  v_cvt_pk_bf16_f32 v51, v70, v71
  v_cvt_pk_bf16_f32 v52, v72, v73
  v_cvt_pk_bf16_f32 v53, v74, v75
  v_cvt_pk_bf16_f32 v54, v76, v77
  v_cvt_pk_bf16_f32 v55, v78, v79
  v_cndmask_b32 v54, v54, v3, s[66:67]
  v_cndmask_b32 v55, v55, v4, s[66:67]
  buffer_store_dwordx4 v[48:51], v2, s[20:23], s52 offen offset:0 sc1
  buffer_store_dwordx4 v[52:55], v2, s[20:23], s52 offen offset:1024 sc1
  v_mfma_f32_32x32x16_bf16 v[80:95], v[96:99], a[96:99], v[80:95]
  v_mfma_f32_32x32x16_bf16 v[80:95], v[100:103], a[100:103], v[80:95]
  v_mfma_f32_32x32x16_bf16 v[80:95], v[104:107], a[104:107], v[80:95]
  v_mfma_f32_32x32x16_bf16 v[80:95], v[108:111], a[108:111], v[80:95]
  v_and_b32 v4, 31, v1
  v_lshlrev_b32 v4, 2, v4
  s_lshl_b32 s52, s46, 7
  s_add_u32 s52, s52, 589824
  s_add_u32 s52, s52, s2
  s_nop 7
  v_mul_f32 v3, 0xbfb8aa3b, v80
  v_exp_f32 v3, v3
  s_nop 0
  v_add_f32 v3, 1.0, v3
  v_rcp_f32 v3, v3
  s_nop 0
  buffer_store_dword v3, v4, s[20:23], s52 offen sc1
  s_branch L_akv
L_av:
  s_lshl1_add_u32 s53, s44, s64
  s_lshl2_add_u32 s53, s53, 524288
  v_mul_u32_u24 v161, 0x1100, v0
  v_add_u32 v161, s53, v161
  v_mov_b32 v163, 33554432
  v_cmp_gt_u32 vcc, 32, v0
  s_nop 0
  v_cndmask_b32 v161, v163, v161, vcc
  v_lshrrev_b32 v5, 5, v1
  v_lshlrev_b32 v5, 4, v5
  v_add_u32 v5, 155648, v5
  s_mov_b32 s50, s49
  s_lshl_b32 s69, s50, 7
  v_add_u32 v7, s69, v5
  s_add_u32 s50, s50, 1
  s_cmp_eq_u32 s50, 7
  s_cselect_b32 s50, 0, s50
  s_waitcnt vmcnt(11)
  ds_read_b128 a[0:3], v12 offset:0
  ds_read_b128 a[4:7], v13 offset:0
  ds_read_b128 a[8:11], v14 offset:0
  ds_read_b128 a[12:15], v15 offset:0
  s_barrier
  ds_read_b64_tr_b16 v[32:33], v21 offset:0
  ds_read_b64_tr_b16 v[34:35], v21 offset:256
  ds_read_b64_tr_b16 v[36:37], v21 offset:1024
  ds_read_b64_tr_b16 v[38:39], v21 offset:1280
  ds_read_b64_tr_b16 v[40:41], v21 offset:2048
  ds_read_b64_tr_b16 v[42:43], v21 offset:2304
  ds_read_b64_tr_b16 v[44:45], v21 offset:3072
  ds_read_b64_tr_b16 v[46:47], v21 offset:3328
  s_add_u32 s3, s3, 1
  s_cmp_eq_u32 s3, 7
  s_cselect_b32 s3, 0, s3
  s_mul_i32 s53, s3, s48
  s_add_u32 m0, s92, 126976
  s_add_u32 s53, s53, s54
  buffer_load_dwordx4 v16, s[12:15], s53 offen  lds
  s_lshl_b32 s53, s3, 7
  s_add_u32 m0, s93, 12288
  s_add_u32 s53, s53, s55
  buffer_load_dwordx4 v8, s[8:11], s53 offen offset:0  lds
  buffer_load_dwordx4 v9, s[8:11], s53 offen offset:1024  lds
  buffer_load_dwordx4 v10, s[8:11], s53 offen offset:2048  lds
  buffer_load_dwordx4 v11, s[8:11], s53 offen offset:3072  lds
  s_lshl_b32 s69, s50, 7
  v_add_u32 v7, s69, v5
  s_add_u32 s50, s50, 1
  s_cmp_eq_u32 s50, 7
  s_cselect_b32 s50, 0, s50
  s_waitcnt vmcnt(11)
  s_waitcnt lgkmcnt(0)
  ds_read_b128 a[16:19], v12 offset:4096
  ds_read_b128 a[20:23], v13 offset:4096
  ds_read_b128 a[24:27], v14 offset:4096
  ds_read_b128 a[28:31], v15 offset:4096
  s_barrier
  ds_read_b64_tr_b16 v[48:49], v21 offset:4096
  ds_read_b64_tr_b16 v[50:51], v21 offset:4352
  ds_read_b64_tr_b16 v[52:53], v21 offset:5120
  ds_read_b64_tr_b16 v[54:55], v21 offset:5376
  ds_read_b64_tr_b16 v[56:57], v21 offset:6144
  ds_read_b64_tr_b16 v[58:59], v21 offset:6400
  ds_read_b64_tr_b16 v[60:61], v21 offset:7168
  ds_read_b64_tr_b16 v[62:63], v21 offset:7424
  v_mfma_f32_32x32x16_bf16 v[64:79], a[0:3], v[32:35], 0
  s_add_u32 s3, s3, 1
  s_cmp_eq_u32 s3, 7
  s_cselect_b32 s3, 0, s3
  s_mul_i32 s53, s3, s48
  s_add_u32 m0, s92, 131072
  s_add_u32 s53, s53, s54
  buffer_load_dwordx4 v16, s[12:15], s53 offen  lds
  v_mfma_f32_32x32x16_bf16 v[64:79], a[4:7], v[36:39], v[64:79]
  s_lshl_b32 s53, s3, 7
  s_add_u32 m0, s93, 16384
  s_add_u32 s53, s53, s55
  buffer_load_dwordx4 v8, s[8:11], s53 offen offset:0  lds
  buffer_load_dwordx4 v9, s[8:11], s53 offen offset:1024  lds
  v_mfma_f32_32x32x16_bf16 v[64:79], a[8:11], v[40:43], v[64:79]
  buffer_load_dwordx4 v10, s[8:11], s53 offen offset:2048  lds
  buffer_load_dwordx4 v11, s[8:11], s53 offen offset:3072  lds
  v_mfma_f32_32x32x16_bf16 v[64:79], a[12:15], v[44:47], v[64:79]
  s_lshl_b32 s69, s50, 7
  v_add_u32 v7, s69, v5
  s_add_u32 s50, s50, 1
  s_cmp_eq_u32 s50, 7
  s_cselect_b32 s50, 0, s50
  s_waitcnt vmcnt(11)
  s_waitcnt lgkmcnt(0)
  ds_read_b128 a[32:35], v12 offset:8192
  ds_read_b128 a[36:39], v13 offset:8192
  ds_read_b128 a[40:43], v14 offset:8192
  ds_read_b128 a[44:47], v15 offset:8192
  s_barrier
  ds_read_b64_tr_b16 v[32:33], v21 offset:8192
  ds_read_b64_tr_b16 v[34:35], v21 offset:8448
  ds_read_b64_tr_b16 v[36:37], v21 offset:9216
  ds_read_b64_tr_b16 v[38:39], v21 offset:9472
  ds_read_b64_tr_b16 v[40:41], v21 offset:10240
  ds_read_b64_tr_b16 v[42:43], v21 offset:10496
  ds_read_b64_tr_b16 v[44:45], v21 offset:11264
  ds_read_b64_tr_b16 v[46:47], v21 offset:11520
  v_mfma_f32_32x32x16_bf16 v[64:79], a[16:19], v[48:51], v[64:79]
  s_add_u32 s3, s3, 1
  s_cmp_eq_u32 s3, 7
  s_cselect_b32 s3, 0, s3
  s_mul_i32 s53, s3, s48
  s_add_u32 m0, s92, 135168
  s_add_u32 s53, s53, s54
  buffer_load_dwordx4 v16, s[12:15], s53 offen  lds
  v_mfma_f32_32x32x16_bf16 v[64:79], a[20:23], v[52:55], v[64:79]
  s_lshl_b32 s53, s3, 7
  s_add_u32 m0, s93, 20480
  s_add_u32 s53, s53, s55
  buffer_load_dwordx4 v8, s[8:11], s53 offen offset:0  lds
  buffer_load_dwordx4 v9, s[8:11], s53 offen offset:1024  lds
  v_mfma_f32_32x32x16_bf16 v[64:79], a[24:27], v[56:59], v[64:79]
  buffer_load_dwordx4 v10, s[8:11], s53 offen offset:2048  lds
  buffer_load_dwordx4 v11, s[8:11], s53 offen offset:3072  lds
  v_mfma_f32_32x32x16_bf16 v[64:79], a[28:31], v[60:63], v[64:79]
  s_lshl_b32 s69, s50, 7
  v_add_u32 v7, s69, v5
  s_add_u32 s50, s50, 1
  s_cmp_eq_u32 s50, 7
  s_cselect_b32 s50, 0, s50
  s_waitcnt vmcnt(10)
  s_waitcnt lgkmcnt(0)
  ds_read_b128 a[48:51], v12 offset:12288
  ds_read_b128 a[52:55], v13 offset:12288
  ds_read_b128 a[56:59], v14 offset:12288
  ds_read_b128 a[60:63], v15 offset:12288
  s_barrier
  ds_read_b64_tr_b16 v[48:49], v21 offset:12288
  ds_read_b64_tr_b16 v[50:51], v21 offset:12544
  ds_read_b64_tr_b16 v[52:53], v21 offset:13312
  ds_read_b64_tr_b16 v[54:55], v21 offset:13568
  ds_read_b64_tr_b16 v[56:57], v21 offset:14336
  ds_read_b64_tr_b16 v[58:59], v21 offset:14592
  ds_read_b64_tr_b16 v[60:61], v21 offset:15360
  ds_read_b64_tr_b16 v[62:63], v21 offset:15616
  v_mfma_f32_32x32x16_bf16 v[64:79], a[32:35], v[32:35], v[64:79]
  s_add_u32 s3, s3, 1
  s_cmp_eq_u32 s3, 7
  s_cselect_b32 s3, 0, s3
  s_mul_i32 s53, s3, s48
  s_add_u32 m0, s92, 139264
  s_add_u32 s53, s53, s54
  buffer_load_dwordx4 v16, s[12:15], s53 offen  lds
  v_mfma_f32_32x32x16_bf16 v[64:79], a[36:39], v[36:39], v[64:79]
  s_lshl_b32 s53, s3, 7
  s_add_u32 m0, s93, 24576
  s_add_u32 s53, s53, s55
  buffer_load_dwordx4 v8, s[8:11], s53 offen offset:0  lds
  buffer_load_dwordx4 v9, s[8:11], s53 offen offset:1024  lds
  v_mfma_f32_32x32x16_bf16 v[64:79], a[40:43], v[40:43], v[64:79]
  buffer_load_dwordx4 v10, s[8:11], s53 offen offset:2048  lds
  buffer_load_dwordx4 v11, s[8:11], s53 offen offset:3072  lds
  v_mfma_f32_32x32x16_bf16 v[64:79], a[44:47], v[44:47], v[64:79]
  s_lshl_b32 s69, s50, 7
  v_add_u32 v7, s69, v5
  s_add_u32 s50, s50, 1
  s_cmp_eq_u32 s50, 7
  s_cselect_b32 s50, 0, s50
  s_waitcnt vmcnt(10)
  s_waitcnt lgkmcnt(0)
  ds_read_b128 a[64:67], v12 offset:16384
  ds_read_b128 a[68:71], v13 offset:16384
  ds_read_b128 a[72:75], v14 offset:16384
  ds_read_b128 a[76:79], v15 offset:16384
  s_barrier
  ds_read_b64_tr_b16 v[32:33], v21 offset:16384
  ds_read_b64_tr_b16 v[34:35], v21 offset:16640
  ds_read_b64_tr_b16 v[36:37], v21 offset:17408
  ds_read_b64_tr_b16 v[38:39], v21 offset:17664
  ds_read_b64_tr_b16 v[40:41], v21 offset:18432
  ds_read_b64_tr_b16 v[42:43], v21 offset:18688
  ds_read_b64_tr_b16 v[44:45], v21 offset:19456
  ds_read_b64_tr_b16 v[46:47], v21 offset:19712
  v_mfma_f32_32x32x16_bf16 v[64:79], a[48:51], v[48:51], v[64:79]
  s_mov_b32 s3, s49
  s_mul_i32 s53, s3, 57344
  s_add_u32 m0, s47, 0
  s_add_u32 s53, s53, s51
  buffer_load_dwordx4 v17, s[16:19], s53 offen lds
  v_mfma_f32_32x32x16_bf16 v[64:79], a[52:55], v[52:55], v[64:79]
  s_add_u32 s3, s3, 1
  s_cmp_eq_u32 s3, 7
  s_cselect_b32 s3, 0, s3
  s_mul_i32 s53, s3, 57344
  s_add_u32 m0, s47, 1024
  s_add_u32 s53, s53, s51
  buffer_load_dwordx4 v17, s[16:19], s53 offen lds
  v_mfma_f32_32x32x16_bf16 v[64:79], a[56:59], v[56:59], v[64:79]
  s_add_u32 s3, s3, 1
  s_cmp_eq_u32 s3, 7
  s_cselect_b32 s3, 0, s3
  s_mul_i32 s53, s3, 57344
  s_add_u32 m0, s47, 2048
  s_add_u32 s53, s53, s51
  buffer_load_dwordx4 v17, s[16:19], s53 offen lds
  v_mfma_f32_32x32x16_bf16 v[64:79], a[60:63], v[60:63], v[64:79]
  s_add_u32 s3, s3, 1
  s_cmp_eq_u32 s3, 7
  s_cselect_b32 s3, 0, s3
  s_mul_i32 s53, s3, 57344
  s_add_u32 m0, s47, 3072
  s_add_u32 s53, s53, s51
  buffer_load_dwordx4 v17, s[16:19], s53 offen lds
  s_add_u32 s3, s3, 1
  s_cmp_eq_u32 s3, 7
  s_cselect_b32 s3, 0, s3
  s_mul_i32 s53, s3, 57344
  s_add_u32 m0, s47, 4096
  s_add_u32 s53, s53, s51
  buffer_load_dwordx4 v17, s[16:19], s53 offen lds
  s_add_u32 s3, s3, 1
  s_cmp_eq_u32 s3, 7
  s_cselect_b32 s3, 0, s3
  s_mul_i32 s53, s3, 57344
  s_add_u32 m0, s47, 5120
  s_add_u32 s53, s53, s51
  buffer_load_dwordx4 v17, s[16:19], s53 offen lds
  s_add_u32 s3, s3, 1
  s_cmp_eq_u32 s3, 7
  s_cselect_b32 s3, 0, s3
  s_mul_i32 s53, s3, 57344
  s_add_u32 m0, s47, 6144
  s_add_u32 s53, s53, s51
  buffer_load_dwordx4 v17, s[16:19], s53 offen lds
  s_lshl_b32 s69, s50, 7
  v_add_u32 v7, s69, v5
  s_add_u32 s50, s50, 1
  s_cmp_eq_u32 s50, 7
  s_cselect_b32 s50, 0, s50
  s_waitcnt vmcnt(12)
  buffer_load_dword v28, v162, s[32:35], 0 offen offset:128 sc1
  s_waitcnt lgkmcnt(0)
  ds_read_b128 a[80:83], v12 offset:20480
  ds_read_b128 a[84:87], v13 offset:20480
  ds_read_b128 a[88:91], v14 offset:20480
  ds_read_b128 a[92:95], v15 offset:20480
  s_barrier
  ds_read_b64_tr_b16 v[48:49], v21 offset:20480
  ds_read_b64_tr_b16 v[50:51], v21 offset:20736
  ds_read_b64_tr_b16 v[52:53], v21 offset:21504
  ds_read_b64_tr_b16 v[54:55], v21 offset:21760
  ds_read_b64_tr_b16 v[56:57], v21 offset:22528
  ds_read_b64_tr_b16 v[58:59], v21 offset:22784
  ds_read_b64_tr_b16 v[60:61], v21 offset:23552
  ds_read_b64_tr_b16 v[62:63], v21 offset:23808
  v_mfma_f32_32x32x16_bf16 v[64:79], a[64:67], v[32:35], v[64:79]
  v_mfma_f32_32x32x16_bf16 v[64:79], a[68:71], v[36:39], v[64:79]
  v_mfma_f32_32x32x16_bf16 v[64:79], a[72:75], v[40:43], v[64:79]
  v_mfma_f32_32x32x16_bf16 v[64:79], a[76:79], v[44:47], v[64:79]
  s_lshl_b32 s69, s50, 7
  v_add_u32 v7, s69, v5
  s_add_u32 s50, s50, 1
  s_cmp_eq_u32 s50, 7
  s_cselect_b32 s50, 0, s50
  s_waitcnt vmcnt(8)
  s_waitcnt lgkmcnt(0)
  ds_read_b128 a[96:99], v12 offset:24576
  ds_read_b128 a[100:103], v13 offset:24576
  ds_read_b128 a[104:107], v14 offset:24576
  ds_read_b128 a[108:111], v15 offset:24576
  s_barrier
  ds_read_b64_tr_b16 v[32:33], v21 offset:24576
  ds_read_b64_tr_b16 v[34:35], v21 offset:24832
  ds_read_b64_tr_b16 v[36:37], v21 offset:25600
  ds_read_b64_tr_b16 v[38:39], v21 offset:25856
  ds_read_b64_tr_b16 v[40:41], v21 offset:26624
  ds_read_b64_tr_b16 v[42:43], v21 offset:26880
  ds_read_b64_tr_b16 v[44:45], v21 offset:27648
  ds_read_b64_tr_b16 v[46:47], v21 offset:27904
  v_mfma_f32_32x32x16_bf16 v[64:79], a[80:83], v[48:51], v[64:79]
  v_mfma_f32_32x32x16_bf16 v[64:79], a[84:87], v[52:55], v[64:79]
  v_mfma_f32_32x32x16_bf16 v[64:79], a[88:91], v[56:59], v[64:79]
  v_mfma_f32_32x32x16_bf16 v[64:79], a[92:95], v[60:63], v[64:79]
  s_waitcnt lgkmcnt(0)
  v_mfma_f32_32x32x16_bf16 v[64:79], a[96:99], v[32:35], v[64:79]
  v_mfma_f32_32x32x16_bf16 v[64:79], a[100:103], v[36:39], v[64:79]
  v_mfma_f32_32x32x16_bf16 v[64:79], a[104:107], v[40:43], v[64:79]
  v_mfma_f32_32x32x16_bf16 v[64:79], a[108:111], v[44:47], v[64:79]
  v_and_b32 v3, 31, v1
  v_mov_b32 v4, 0x3f803f80
  v_cmp_eq_u32 vcc, 28, v3
  s_nop 1
  v_cndmask_b32 v4, 0, v4, vcc
  v_cmp_gt_u32 vcc, 28, v3
  s_nop 7
  v_cvt_pk_bf16_f32 v48, v64, v65
  v_cvt_pk_bf16_f32 v49, v66, v67
  v_cvt_pk_bf16_f32 v50, v68, v69
  v_cvt_pk_bf16_f32 v51, v70, v71
  v_cvt_pk_bf16_f32 v52, v72, v73
  v_cvt_pk_bf16_f32 v53, v74, v75
  v_cvt_pk_bf16_f32 v54, v76, v77
  v_cvt_pk_bf16_f32 v55, v78, v79
  v_cndmask_b32 v48, v4, v48, vcc
  v_cndmask_b32 v49, v4, v49, vcc
  v_cndmask_b32 v50, v4, v50, vcc
  v_cndmask_b32 v51, v4, v51, vcc
  v_cndmask_b32 v52, v4, v52, vcc
  v_cndmask_b32 v53, v4, v53, vcc
  v_cndmask_b32 v54, v4, v54, vcc
  v_cndmask_b32 v55, v4, v55, vcc
  s_lshl_b32 s52, s56, 12
  s_add_u32 s52, s52, 2048
  buffer_store_dwordx4 v[48:51], v2, s[20:23], s52 offen offset:0 sc1
  buffer_store_dwordx4 v[52:55], v2, s[20:23], s52 offen offset:1024 sc1
L_akv:
  s_waitcnt vmcnt(0)
  s_cmp_lg_u32 s46, 0
  s_cbranch_scc1 L_ok0b
  v_readfirstlane_b32 s52, v28
  s_cmp_ge_u32 s52, 16
  s_cbranch_scc0 L_sp0b
L_ok0b:
  s_barrier
  v_mov_b32 v3, 1
  v_lshlrev_b32 v6, 8, v0
  buffer_store_dword v248, v161, s[20:23], 0 offen sc1
  s_lshl4_add_u32 s50, s46, s45
  s_lshl_b32 s50, s50, 11
  s_add_u32 s50, s50, 458752
  s_add_u32 s50, s50, s2
  v_mov_b32 v164, -1
  v_mov_b32 v165, -1
  v_mov_b32 v166, -1
  v_mov_b32 v167, -1
  buffer_store_dwordx4 v[164:167], v2, s[20:23], s50 offen offset:0 sc1
  buffer_store_dwordx4 v[164:167], v2, s[20:23], s50 offen offset:1024 sc1
  ds_read_b64_tr_b16 v[32:33], v24 offset:0
  ds_read_b64_tr_b16 v[34:35], v24 offset:256
  ds_read_b64_tr_b16 v[36:37], v24 offset:28672
  ds_read_b64_tr_b16 v[38:39], v24 offset:28928
  ds_read_b64_tr_b16 v[40:41], v25 offset:0
  ds_read_b64_tr_b16 v[42:43], v25 offset:256
  ds_read_b64_tr_b16 v[44:45], v25 offset:28672
  ds_read_b64_tr_b16 v[46:47], v25 offset:28928
  s_waitcnt lgkmcnt(0)
  ds_read_b64_tr_b16 v[48:49], v24 offset:1024
  ds_read_b64_tr_b16 v[50:51], v24 offset:1280
  ds_read_b64_tr_b16 v[52:53], v24 offset:29696
  ds_read_b64_tr_b16 v[54:55], v24 offset:29952
  ds_read_b64_tr_b16 v[56:57], v25 offset:1024
  ds_read_b64_tr_b16 v[58:59], v25 offset:1280
  ds_read_b64_tr_b16 v[60:61], v25 offset:29696
  ds_read_b64_tr_b16 v[62:63], v25 offset:29952
  v_mfma_f32_32x32x16_bf16 v[128:143], v[32:35], a[0:3], 0
  v_mfma_f32_32x32x16_bf16 v[128:143], v[36:39], a[4:7], v[128:143]
  v_mfma_f32_32x32x16_bf16 v[128:143], v[40:43], a[8:11], v[128:143]
  v_mfma_f32_32x32x16_bf16 v[128:143], v[44:47], a[12:15], v[128:143]
  s_waitcnt lgkmcnt(0)
  ds_read_b64_tr_b16 v[32:33], v24 offset:2048
  ds_read_b64_tr_b16 v[34:35], v24 offset:2304
  ds_read_b64_tr_b16 v[36:37], v24 offset:30720
  ds_read_b64_tr_b16 v[38:39], v24 offset:30976
  ds_read_b64_tr_b16 v[40:41], v25 offset:2048
  ds_read_b64_tr_b16 v[42:43], v25 offset:2304
  ds_read_b64_tr_b16 v[44:45], v25 offset:30720
  ds_read_b64_tr_b16 v[46:47], v25 offset:30976
  v_mfma_f32_32x32x16_bf16 v[128:143], v[48:51], a[16:19], v[128:143]
  v_mfma_f32_32x32x16_bf16 v[128:143], v[52:55], a[20:23], v[128:143]
  v_mfma_f32_32x32x16_bf16 v[128:143], v[56:59], a[24:27], v[128:143]
  v_mfma_f32_32x32x16_bf16 v[128:143], v[60:63], a[28:31], v[128:143]
  s_waitcnt lgkmcnt(0)
  ds_read_b64_tr_b16 v[48:49], v24 offset:3072
  ds_read_b64_tr_b16 v[50:51], v24 offset:3328
  ds_read_b64_tr_b16 v[52:53], v24 offset:31744
  ds_read_b64_tr_b16 v[54:55], v24 offset:32000
  ds_read_b64_tr_b16 v[56:57], v25 offset:3072
  ds_read_b64_tr_b16 v[58:59], v25 offset:3328
  ds_read_b64_tr_b16 v[60:61], v25 offset:31744
  ds_read_b64_tr_b16 v[62:63], v25 offset:32000
  v_mfma_f32_32x32x16_bf16 v[128:143], v[32:35], a[32:35], v[128:143]
  v_mfma_f32_32x32x16_bf16 v[128:143], v[36:39], a[36:39], v[128:143]
  v_mfma_f32_32x32x16_bf16 v[128:143], v[40:43], a[40:43], v[128:143]
  v_mfma_f32_32x32x16_bf16 v[128:143], v[44:47], a[44:47], v[128:143]
  s_waitcnt lgkmcnt(0)
  ds_read_b64_tr_b16 v[32:33], v24 offset:4096
  ds_read_b64_tr_b16 v[34:35], v24 offset:4352
  ds_read_b64_tr_b16 v[36:37], v24 offset:32768
  ds_read_b64_tr_b16 v[38:39], v24 offset:33024
  ds_read_b64_tr_b16 v[40:41], v25 offset:4096
  ds_read_b64_tr_b16 v[42:43], v25 offset:4352
  ds_read_b64_tr_b16 v[44:45], v25 offset:32768
  ds_read_b64_tr_b16 v[46:47], v25 offset:33024
  v_mfma_f32_32x32x16_bf16 v[128:143], v[48:51], a[48:51], v[128:143]
  v_mfma_f32_32x32x16_bf16 v[128:143], v[52:55], a[52:55], v[128:143]
  v_mfma_f32_32x32x16_bf16 v[128:143], v[56:59], a[56:59], v[128:143]
  v_mfma_f32_32x32x16_bf16 v[128:143], v[60:63], a[60:63], v[128:143]
  s_waitcnt lgkmcnt(0)
  ds_read_b64_tr_b16 v[48:49], v24 offset:5120
  ds_read_b64_tr_b16 v[50:51], v24 offset:5376
  ds_read_b64_tr_b16 v[52:53], v24 offset:33792
  ds_read_b64_tr_b16 v[54:55], v24 offset:34048
  ds_read_b64_tr_b16 v[56:57], v25 offset:5120
  ds_read_b64_tr_b16 v[58:59], v25 offset:5376
  ds_read_b64_tr_b16 v[60:61], v25 offset:33792
  ds_read_b64_tr_b16 v[62:63], v25 offset:34048
  v_mfma_f32_32x32x16_bf16 v[128:143], v[32:35], a[64:67], v[128:143]
  v_mfma_f32_32x32x16_bf16 v[128:143], v[36:39], a[68:71], v[128:143]
  v_mfma_f32_32x32x16_bf16 v[128:143], v[40:43], a[72:75], v[128:143]
  v_mfma_f32_32x32x16_bf16 v[128:143], v[44:47], a[76:79], v[128:143]
  s_waitcnt lgkmcnt(0)
  ds_read_b64_tr_b16 v[32:33], v24 offset:6144
  ds_read_b64_tr_b16 v[34:35], v24 offset:6400
  ds_read_b64_tr_b16 v[36:37], v24 offset:34816
  ds_read_b64_tr_b16 v[38:39], v24 offset:35072
  ds_read_b64_tr_b16 v[40:41], v25 offset:6144
  ds_read_b64_tr_b16 v[42:43], v25 offset:6400
  ds_read_b64_tr_b16 v[44:45], v25 offset:34816
  ds_read_b64_tr_b16 v[46:47], v25 offset:35072
  buffer_load_dword v28, v160, s[20:23], 0 offen sc1
  v_mfma_f32_32x32x16_bf16 v[128:143], v[48:51], a[80:83], v[128:143]
  v_mfma_f32_32x32x16_bf16 v[128:143], v[52:55], a[84:87], v[128:143]
  v_mfma_f32_32x32x16_bf16 v[128:143], v[56:59], a[88:91], v[128:143]
  v_mfma_f32_32x32x16_bf16 v[128:143], v[60:63], a[92:95], v[128:143]
  s_waitcnt lgkmcnt(0)
  v_mfma_f32_32x32x16_bf16 v[128:143], v[32:35], a[96:99], v[128:143]
  v_mfma_f32_32x32x16_bf16 v[128:143], v[36:39], a[100:103], v[128:143]
  v_mfma_f32_32x32x16_bf16 v[128:143], v[40:43], a[104:107], v[128:143]
  v_mfma_f32_32x32x16_bf16 v[128:143], v[44:47], a[108:111], v[128:143]
  s_barrier
  s_waitcnt vmcnt(0)
  v_cmp_eq_u32 vcc, 1, v28
  s_cmp_eq_u64 vcc, -1
  s_cbranch_scc0 L_sp1b
L_ok1b:
  global_load_dwordx4 v[232:235], v2, s[98:99] offset:0 sc1
  global_load_dwordx4 v[236:239], v2, s[98:99] offset:1024 sc1
  s_lshl_b32 s53, s46, 16
  s_add_u32 s53, s53, 4096
  s_add_u32 s36, s98, s53
  s_addc_u32 s37, s99, 0
  global_load_dwordx4 v[168:171], v2, s[36:37] offset:-4096 sc1
  global_load_dwordx4 v[172:175], v2, s[36:37] offset:-3072 sc1
  global_load_dwordx4 v[176:179], v2, s[36:37] offset:-2048 sc1
  global_load_dwordx4 v[180:183], v2, s[36:37] offset:-1024 sc1
  global_load_dwordx4 v[184:187], v2, s[36:37] offset:0 sc1
  global_load_dwordx4 v[188:191], v2, s[36:37] offset:1024 sc1
  global_load_dwordx4 v[192:195], v2, s[36:37] offset:2048 sc1
  global_load_dwordx4 v[196:199], v2, s[36:37] offset:3072 sc1
  s_add_u32 s36, s36, 8192
  s_addc_u32 s37, s37, 0
  global_load_dwordx4 v[200:203], v2, s[36:37] offset:-4096 sc1
  global_load_dwordx4 v[204:207], v2, s[36:37] offset:-3072 sc1
  global_load_dwordx4 v[208:211], v2, s[36:37] offset:-2048 sc1
  global_load_dwordx4 v[212:215], v2, s[36:37] offset:-1024 sc1
  s_branch L_join
L_sp0:
  s_mov_b32 s69, 0
  s_cmp_lg_u32 s46, 0
  s_cbranch_scc1 L_ok0
L_sq0:
  s_sleep 8
  buffer_load_dword v28, v162, s[32:35], 0 offen sc1
  s_add_u32 s69, s69, 1
  s_waitcnt vmcnt(0)
  s_cmp_ge_u32 s69, 0x40000
  s_cbranch_scc1 L_ok0
  v_readfirstlane_b32 s52, v28
  s_cmp_ge_u32 s52, 16
  s_cbranch_scc0 L_sq0
  s_branch L_ok0
L_sp1:
  s_mov_b32 s69, 0

L_sq1:
  s_sleep 8
  buffer_load_dword v28, v160, s[20:23], 0 offen sc1
  s_add_u32 s69, s69, 1
  s_waitcnt vmcnt(0)
  s_cmp_ge_u32 s69, 0x40000
  s_cbranch_scc1 L_ok1
  v_cmp_eq_u32 vcc, 1, v28
  s_cmp_eq_u64 vcc, -1
  s_cbranch_scc0 L_sq1
  s_branch L_ok1
L_sp2:
  s_mov_b32 s69, 0

L_sq2:
  s_sleep 8
  buffer_load_dword v28, v250, s[20:23], s58 offen sc1
  s_add_u32 s69, s69, 1
  s_waitcnt vmcnt(0)
  s_cmp_ge_u32 s69, 0x40000
  s_cbranch_scc1 L_ok2
  v_readfirstlane_b32 s52, v28
  s_cmp_ge_u32 s52, 64
  s_cbranch_scc0 L_sq2
  s_branch L_ok2
L_idle:
  s_waitcnt vmcnt(0) lgkmcnt(0)
  s_branch L_fin
L_oretry1:
  s_add_u32 s69, s69, 1
  s_cmp_ge_u32 s69, 0x10000
  s_cbranch_scc1 L_ook1
  global_load_dwordx4 v[68:71], v247, s[38:39] offset:-4096 sc1
  global_load_dwordx4 v[76:79], v247, s[38:39] offset:-3072 sc1
  global_load_dwordx4 v[84:87], v247, s[38:39] offset:-2048 sc1
  global_load_dwordx4 v[92:95], v247, s[38:39] offset:-1024 sc1
  global_load_dwordx4 v[100:103], v247, s[38:39] offset:0 sc1
  global_load_dwordx4 v[108:111], v247, s[38:39] offset:1024 sc1
  global_load_dwordx4 v[116:119], v247, s[38:39] offset:2048 sc1
  global_load_dwordx4 v[124:127], v247, s[38:39] offset:3072 sc1
  s_waitcnt vmcnt(0)
  v_max3_u32 v11, v68, v69, v70
  v_max3_u32 v12, v71, v76, v77
  v_max3_u32 v12, v12, v78, v79
  v_max3_u32 v11, v11, v84, v85
  v_max3_u32 v12, v12, v86, v87
  v_max3_u32 v11, v11, v92, v93
  v_max3_u32 v12, v12, v94, v95
  v_max3_u32 v11, v11, v100, v101
  v_max3_u32 v12, v12, v102, v103
  v_max3_u32 v11, v11, v108, v109
  v_max3_u32 v12, v12, v110, v111
  v_max3_u32 v11, v11, v116, v117
  v_max3_u32 v12, v12, v118, v119
  v_max3_u32 v11, v11, v124, v125
  v_max3_u32 v12, v12, v126, v127
  v_max_u32 v11, v11, v12
  v_cmp_eq_u32 vcc, -1, v11
  s_nop 1
  s_cbranch_vccnz L_oretry1
  s_branch L_ook1
L_oretry0:
  s_add_u32 s69, s69, 1
  s_cmp_ge_u32 s69, 0x10000
  s_cbranch_scc1 L_ook0
  global_load_dwordx4 v[64:67], v246, s[38:39] offset:-4096 sc1
  global_load_dwordx4 v[72:75], v246, s[38:39] offset:-3072 sc1
  global_load_dwordx4 v[80:83], v246, s[38:39] offset:-2048 sc1
  global_load_dwordx4 v[88:91], v246, s[38:39] offset:-1024 sc1
  global_load_dwordx4 v[96:99], v246, s[38:39] offset:0 sc1
  global_load_dwordx4 v[104:107], v246, s[38:39] offset:1024 sc1
  global_load_dwordx4 v[112:115], v246, s[38:39] offset:2048 sc1
  global_load_dwordx4 v[120:123], v246, s[38:39] offset:3072 sc1
  s_waitcnt vmcnt(0)
  v_max3_u32 v11, v64, v65, v66
  v_max3_u32 v12, v67, v72, v73
  v_max3_u32 v12, v12, v74, v75
  v_max3_u32 v11, v11, v80, v81
  v_max3_u32 v12, v12, v82, v83
  v_max3_u32 v11, v11, v88, v89
  v_max3_u32 v12, v12, v90, v91
  v_max3_u32 v11, v11, v96, v97
  v_max3_u32 v12, v12, v98, v99
  v_max3_u32 v11, v11, v104, v105
  v_max3_u32 v12, v12, v106, v107
  v_max3_u32 v11, v11, v112, v113
  v_max3_u32 v12, v12, v114, v115
  v_max3_u32 v11, v11, v120, v121
  v_max3_u32 v12, v12, v122, v123
  v_max_u32 v11, v11, v12
  v_cmp_eq_u32 vcc, -1, v11
  s_nop 1
  s_cbranch_vccnz L_oretry0
  s_branch L_ook0
L_fb:
  s_cmp_lg_u32 s57, 0
  s_cbranch_scc1 L_fbok
  s_mov_b32 s57, 1
  s_waitcnt vmcnt(0) lgkmcnt(0)
  s_nop 15
  s_mov_b32 s50, 33554432
  s_mov_b32 s48, 33554432
  s_mov_b32 s51, 33554432
  v_mov_b32 v160, 0xff800000
  v_cndmask_b32 v38, v38, 0, s[66:67]
  v_cndmask_b32 v39, v39, 0, s[66:67]
  v_mov_b32 v161, 0xff800000
  v_cndmask_b32 v46, v46, 0, s[66:67]
  v_cndmask_b32 v47, v47, 0, s[66:67]
  v_mov_b32 v162, 0xff800000
  v_cndmask_b32 v54, v54, 0, s[66:67]
  v_cndmask_b32 v55, v55, 0, s[66:67]
  v_mov_b32 v163, 0xff800000
  v_cndmask_b32 v62, v62, 0, s[66:67]
  v_cndmask_b32 v63, v63, 0, s[66:67]
  s_lshl_b32 s55, s46, 16
  s_mov_b32 s54, 16
L_fbl:
  buffer_load_dwordx4 v[232:235], v2, s[20:23], s55 offen offset:0 sc1
  buffer_load_dwordx4 v[236:239], v2, s[20:23], s55 offen offset:1024 sc1
  s_waitcnt vmcnt(0)
  v_mfma_f32_32x32x16_bf16 v[128:143], v[232:235], v[32:35], 0
  v_mfma_f32_32x32x16_bf16 v[128:143], v[236:239], v[36:39], v[128:143]
  s_nop 15
  v_max3_f32 v160, v160, v128, v129
  v_max3_f32 v160, v160, v130, v131
  v_max3_f32 v160, v160, v132, v133
  v_max3_f32 v160, v160, v134, v135
  v_max3_f32 v160, v160, v136, v137
  v_max3_f32 v160, v160, v138, v139
  v_max3_f32 v160, v160, v140, v141
  v_max3_f32 v160, v160, v142, v143
  v_mfma_f32_32x32x16_bf16 v[128:143], v[232:235], v[40:43], 0
  v_mfma_f32_32x32x16_bf16 v[128:143], v[236:239], v[44:47], v[128:143]
  s_nop 15
  v_max3_f32 v161, v161, v128, v129
  v_max3_f32 v161, v161, v130, v131
  v_max3_f32 v161, v161, v132, v133
  v_max3_f32 v161, v161, v134, v135
  v_max3_f32 v161, v161, v136, v137
  v_max3_f32 v161, v161, v138, v139
  v_max3_f32 v161, v161, v140, v141
  v_max3_f32 v161, v161, v142, v143
  v_mfma_f32_32x32x16_bf16 v[128:143], v[232:235], v[48:51], 0
  v_mfma_f32_32x32x16_bf16 v[128:143], v[236:239], v[52:55], v[128:143]
  s_nop 15
  v_max3_f32 v162, v162, v128, v129
  v_max3_f32 v162, v162, v130, v131
  v_max3_f32 v162, v162, v132, v133
  v_max3_f32 v162, v162, v134, v135
  v_max3_f32 v162, v162, v136, v137
  v_max3_f32 v162, v162, v138, v139
  v_max3_f32 v162, v162, v140, v141
  v_max3_f32 v162, v162, v142, v143
  v_mfma_f32_32x32x16_bf16 v[128:143], v[232:235], v[56:59], 0
  v_mfma_f32_32x32x16_bf16 v[128:143], v[236:239], v[60:63], v[128:143]
  s_nop 15
  v_max3_f32 v163, v163, v128, v129
  v_max3_f32 v163, v163, v130, v131
  v_max3_f32 v163, v163, v132, v133
  v_max3_f32 v163, v163, v134, v135
  v_max3_f32 v163, v163, v136, v137
  v_max3_f32 v163, v163, v138, v139
  v_max3_f32 v163, v163, v140, v141
  v_max3_f32 v163, v163, v142, v143
  s_add_u32 s55, s55, 4096
  s_sub_u32 s54, s54, 1
  s_cmp_lg_u32 s54, 0
  s_cbranch_scc1 L_fbl
  s_barrier
  v_lshlrev_b32 v5, 2, v1
  v_mov_b32 v3, v160
  s_nop 1
  v_permlane32_swap_b32 v3, v160
  s_nop 1
  v_max_f32 v160, v160, v3
  s_add_u32 s52, s46, 0
  s_and_b32 s52, s52, 3
  s_lshl_b32 s52, s52, 10
  s_add_u32 s52, s52, 114688
  v_add_u32 v128, s52, v5
  ds_write_b32 v128, v160 offset:0
  v_mov_b32 v3, v161
  s_nop 1
  v_permlane32_swap_b32 v3, v161
  s_nop 1
  v_max_f32 v161, v161, v3
  s_add_u32 s52, s46, 1
  s_and_b32 s52, s52, 3
  s_lshl_b32 s52, s52, 10
  s_add_u32 s52, s52, 114688
  v_add_u32 v129, s52, v5
  ds_write_b32 v129, v161 offset:256
  v_mov_b32 v3, v162
  s_nop 1
  v_permlane32_swap_b32 v3, v162
  s_nop 1
  v_max_f32 v162, v162, v3
  s_add_u32 s52, s46, 2
  s_and_b32 s52, s52, 3
  s_lshl_b32 s52, s52, 10
  s_add_u32 s52, s52, 114688
  v_add_u32 v130, s52, v5
  ds_write_b32 v130, v162 offset:512
  v_mov_b32 v3, v163
  s_nop 1
  v_permlane32_swap_b32 v3, v163
  s_nop 1
  v_max_f32 v163, v163, v3
  s_add_u32 s52, s46, 3
  s_and_b32 s52, s52, 3
  s_lshl_b32 s52, s52, 10
  s_add_u32 s52, s52, 114688
  v_add_u32 v131, s52, v5
  ds_write_b32 v131, v163 offset:768
  s_waitcnt lgkmcnt(0)
  s_barrier
  ds_read_b32 v132, v128 offset:0
  ds_read_b32 v133, v128 offset:256
  ds_read_b32 v134, v128 offset:512
  ds_read_b32 v135, v128 offset:768
  s_waitcnt lgkmcnt(0)
  v_max3_f32 v160, v132, v133, v134
  v_max_f32 v160, v160, v135
  v_sub_f32 v160, 0, v160
  v_and_b32 v3, 0xffff0000, v160
  v_sub_f32 v160, v160, v3
  v_and_b32 v4, 0xffff0000, v160
  v_sub_f32 v160, v160, v4
  v_lshrrev_b32 v3, 16, v3
  v_or_b32 v3, v3, v4
  v_lshrrev_b32 v160, 16, v160
  v_cndmask_b32 v38, v38, v3, s[66:67]
  v_cndmask_b32 v39, v39, v160, s[66:67]
  ds_read_b32 v132, v129 offset:0
  ds_read_b32 v133, v129 offset:256
  ds_read_b32 v134, v129 offset:512
  ds_read_b32 v135, v129 offset:768
  s_waitcnt lgkmcnt(0)
  v_max3_f32 v161, v132, v133, v134
  v_max_f32 v161, v161, v135
  v_sub_f32 v161, 0, v161
  v_and_b32 v3, 0xffff0000, v161
  v_sub_f32 v161, v161, v3
  v_and_b32 v4, 0xffff0000, v161
  v_sub_f32 v161, v161, v4
  v_lshrrev_b32 v3, 16, v3
  v_or_b32 v3, v3, v4
  v_lshrrev_b32 v161, 16, v161
  v_cndmask_b32 v46, v46, v3, s[66:67]
  v_cndmask_b32 v47, v47, v161, s[66:67]
  ds_read_b32 v132, v130 offset:0
  ds_read_b32 v133, v130 offset:256
  ds_read_b32 v134, v130 offset:512
  ds_read_b32 v135, v130 offset:768
  s_waitcnt lgkmcnt(0)
  v_max3_f32 v162, v132, v133, v134
  v_max_f32 v162, v162, v135
  v_sub_f32 v162, 0, v162
  v_and_b32 v3, 0xffff0000, v162
  v_sub_f32 v162, v162, v3
  v_and_b32 v4, 0xffff0000, v162
  v_sub_f32 v162, v162, v4
  v_lshrrev_b32 v3, 16, v3
  v_or_b32 v3, v3, v4
  v_lshrrev_b32 v162, 16, v162
  v_cndmask_b32 v54, v54, v3, s[66:67]
  v_cndmask_b32 v55, v55, v162, s[66:67]
  ds_read_b32 v132, v131 offset:0
  ds_read_b32 v133, v131 offset:256
  ds_read_b32 v134, v131 offset:512
  ds_read_b32 v135, v131 offset:768
  s_waitcnt lgkmcnt(0)
  v_max3_f32 v163, v132, v133, v134
  v_max_f32 v163, v163, v135
  v_sub_f32 v163, 0, v163
  v_and_b32 v3, 0xffff0000, v163
  v_sub_f32 v163, v163, v3
  v_and_b32 v4, 0xffff0000, v163
  v_sub_f32 v163, v163, v4
  v_lshrrev_b32 v3, 16, v3
  v_or_b32 v3, v3, v4
  v_lshrrev_b32 v163, 16, v163
  v_cndmask_b32 v62, v62, v3, s[66:67]
  v_cndmask_b32 v63, v63, v163, s[66:67]
  s_lshl_b32 s53, s46, 16
  s_add_u32 s53, s53, 4096
  s_add_u32 s36, s98, s53
  s_addc_u32 s37, s99, 0
  global_load_dwordx4 v[168:171], v2, s[36:37] offset:-4096 sc1
  global_load_dwordx4 v[172:175], v2, s[36:37] offset:-3072 sc1
  global_load_dwordx4 v[176:179], v2, s[36:37] offset:-2048 sc1
  global_load_dwordx4 v[180:183], v2, s[36:37] offset:-1024 sc1
  global_load_dwordx4 v[184:187], v2, s[36:37] offset:0 sc1
  global_load_dwordx4 v[188:191], v2, s[36:37] offset:1024 sc1
  global_load_dwordx4 v[192:195], v2, s[36:37] offset:2048 sc1
  global_load_dwordx4 v[196:199], v2, s[36:37] offset:3072 sc1
  s_add_u32 s36, s36, 8192
  s_addc_u32 s37, s37, 0
  global_load_dwordx4 v[200:203], v2, s[36:37] offset:-4096 sc1
  global_load_dwordx4 v[204:207], v2, s[36:37] offset:-3072 sc1
  global_load_dwordx4 v[208:211], v2, s[36:37] offset:-2048 sc1
  global_load_dwordx4 v[212:215], v2, s[36:37] offset:-1024 sc1
  s_waitcnt vmcnt(0)
  s_barrier
  s_branch L_attn
L_end:
  s_endpgm
.section .rodata,"a"
.p2align 6
.amdhsa_kernel gated_mix__grouped_kv_mqa__dense_activation_relu__prompt_kernel
  .amdhsa_next_free_vgpr 512
  .amdhsa_next_free_sgpr 102
  .amdhsa_accum_offset 256
  .amdhsa_group_segment_fixed_size 0
  .amdhsa_kernarg_size 96
  .amdhsa_user_sgpr_count 2
  .amdhsa_user_sgpr_kernarg_segment_ptr 1
  .amdhsa_system_sgpr_workgroup_id_x 1
.end_amdhsa_kernel
```
